```python
import torch

def _softmax(x, axis=-1):
    return torch.softmax(x, dim=axis)
def _gelu(x):
    return torch.nn.functional.gelu(x, approximate="tanh")
def _silu(x):
    return torch.nn.functional.silu(x)
def _sigmoid(x):
    return torch.sigmoid(x)
def _layernorm(x, axis=-1, eps=1e-5):
    m = x.mean(dim=axis, keepdim=True)
    v = x.var(dim=axis, keepdim=True, unbiased=False)
    return (x - m) / torch.sqrt(v + eps)
def _scatter_add(tgt, idx, src, axis=0):
    return tgt.clone().index_add_(axis, idx, src)
def _segment_sum(src, seg, n):
    out = torch.zeros((n,) + src.shape[1:], dtype=src.dtype)
    return out.index_add_(0, seg, src)
def _pad(x, pw):
    flat = tuple(v for pair in reversed(pw) for v in pair)
    return torch.nn.functional.pad(x, flat)

kernel_name = 'sequential_preLN__mha_block_cached__dense_activation_squared_relu__decode'

def setup_inputs():

    _w = (lambda a: (lambda t: t.to(torch.bfloat16) if t.is_floating_point() else t)(torch.as_tensor(a)))
    def _A_setup():
        B, Sq, D = 2, 1, 512
        H, Sk, Dh = 32, 4096, 128
        return {
            "x": _w((lambda *s: torch.randn(*s, dtype=torch.bfloat16) * 0.05)(B, Sq, D)),
            "k_cache": _w((lambda *s: torch.randn(*s, dtype=torch.bfloat16) * 3.2)(B, H, Sk, Dh)),
            "v_cache": _w((lambda *s: torch.randn(*s, dtype=torch.bfloat16) * 0.4)(B, H, Sk, Dh)),
            "wq": _w((lambda *s: torch.randn(*s, dtype=torch.bfloat16) * 3.2)(D, H * Dh) * (D ** -0.5)),
            "wo": _w((lambda *s: torch.randn(*s, dtype=torch.bfloat16) * 0.4)(H * Dh, D) * ((H * Dh) ** -0.5)),
        }
    _A_in = _A_setup()

    def _B_setup():
        B, S, D, F = 2, 1, 512, 1376
        return {
            "x": _w((lambda *s: torch.randn(*s, dtype=torch.bfloat16) * 0.05)(B, S, D)),
            "w1": _w((lambda *s: torch.randn(*s, dtype=torch.bfloat16) * 0.05)(D, F)),
            "b1": _w((lambda *s: torch.randn(*s, dtype=torch.bfloat16) * 0.8)(F)),
            "w2": _w((lambda *s: torch.randn(*s, dtype=torch.bfloat16) * 0.05)(F, D)),
            "b2": _w((lambda *s: torch.randn(*s, dtype=torch.bfloat16) * 3.2)(D)),
        }
    _B_in = _B_setup()

    return {
        "A_x": _A_in["x"],
        "A_k_cache": _A_in["k_cache"],
        "A_v_cache": _A_in["v_cache"],
        "A_wq": _A_in["wq"],
        "A_wo": _A_in["wo"],
        "B_x": _B_in["x"],
        "B_w1": _B_in["w1"],
        "B_b1": _B_in["b1"],
        "B_w2": _B_in["w2"],
        "B_b2": _B_in["b2"],
    }

def reference(A_x, A_k_cache, A_v_cache, A_wq, A_wo, B_x, B_w1, B_b1, B_w2, B_b2):
    def _A_ref(x, k_cache, v_cache, wq, wo):
        B, Sq, D = x.shape
        H, Dh = 32, 128
        q = (lambda x, *d: x.permute(*d))((x @ wq).reshape(B, Sq, H, Dh), 0, 2, 1, 3)
        scores = torch.einsum("bhqd,bhkd->bhqk", q, k_cache) * (Dh ** -0.5)
        p = _softmax(scores, axis=-1)
        o = torch.einsum("bhqk,bhkd->bhqd", p, v_cache)
        return (lambda x, *d: x.permute(*d))(o, 0, 2, 1, 3).reshape(B, Sq, H * Dh) @ wo

    def _B_ref(x, w1, b1, w2, b2):
        h = torch.einsum("bsd,df->bsf", x, w1) + b1
        zero = torch.zeros_like(h)
        r = torch.where(h > zero, h, zero)
        h = r * r
        out = torch.einsum("bsf,fd->bsd", h, w2) + b2
        return out

    x = A_x
    h = x + _A_ref(_layernorm(x, axis=-1), A_k_cache, A_v_cache, A_wq, A_wo)
    h2 = h + _B_ref(_layernorm(h, axis=-1), B_w1, B_b1, B_w2, B_b2)
    return h2
```

```asm
; @launch grid=(256,1,1) block=(512,1,1) lds=147456
.amdgcn_target "amdgcn-amd-amdhsa--gfx950"
.text
.globl sequential_preLN__mha_block_cached__dense_activation_squared_relu__decode_kernel
.p2align 8
.type sequential_preLN__mha_block_cached__dense_activation_squared_relu__decode_kernel,@function
sequential_preLN__mha_block_cached__dense_activation_squared_relu__decode_kernel:
    s_load_dwordx2 s[36:37], s[0:1], 8
    s_load_dwordx2 s[32:33], s[0:1], 96
    s_load_dwordx2 s[6:7], s[0:1], 0
    s_lshr_b32 s53, s2, 3
    s_cmp_ge_u32 s53, 32
    s_cbranch_scc1 L_end
    s_getpc_b64 s[34:35]
L_pc:
    v_lshl_add_u32 v30, v0, 5, s53
    v_cmp_gt_u32 vcc, 8, v0
    v_lshlrev_b32 v30, 7, v30
    s_and_b64 exec, exec, vcc
    s_cbranch_scc0 L_nopf
    global_load_dword v30, v30, s[34:35]
L_nopf:
    s_mov_b64 exec, -1
    v_lshrrev_b32 v5, 6, v0
    v_and_b32 v1, 63, v0
    v_lshlrev_b32 v4, 12, v5
    v_lshl_add_u32 v4, v1, 4, v4
    s_and_b32 s52, s2, 7
    s_lshl_b32 s70, s52, 5
    s_add_u32 s70, s70, s53
    s_lshr_b32 s54, s70, 3
    s_and_b32 s56, s53, 4
    s_and_b32 s65, s53, 3
    s_and_b32 s55, s53, 7
    s_lshl3_add_u32 s68, s56, s54
    s_lshl2_add_u32 s68, s68, s65
    s_lshl3_add_u32 s68, s68, s55
    s_lshl_b32 s68, s68, 15
    s_brev_b32 s38, 32
    s_lshl_b32 s39, 1, 17
    v_readfirstlane_b32 s57, v5
    s_lshl_b32 s65, s53, 6
    s_lshl3_add_u32 s76, s52, s57
    s_cmp_lg_u32 s57, 3
    s_waitcnt lgkmcnt(0)
    s_cbranch_scc1 L_nox
    s_load_dword s82, s[6:7], s65
L_nox:
    s_cmp_lg_u32 s76, 2
    s_cbranch_scc1 L_norace
    s_bitset1_b32 s65, 17
    s_load_dword s82, s[32:33], s65
    s_bitset1_b32 s65, 13
    s_load_dword s83, s[32:33], s65
L_norace:
    buffer_load_dwordx4 v[48:51], v4, s[36:39], s68 offen offset:0 nt
    buffer_load_dwordx4 v[52:55], v4, s[36:39], s68 offen offset:2048 nt
    buffer_load_dwordx4 v[56:59], v4, s[36:39], s68 offen offset:1024 nt
    buffer_load_dwordx4 v[60:63], v4, s[36:39], s68 offen offset:3072 nt
    s_waitcnt lgkmcnt(1)
    s_cmp_lg_u32 s57, 0
    s_getreg_b32 s81, hwreg(HW_REG_IB_STS, 8, 1)
    v_lshrrev_b32 v2, 4, v1
    v_and_b32 v3, 15, v1
    s_cbranch_scc1 L_rest
    s_load_dwordx8 s[8:15], s[0:1], 0
    v_lshrrev_b32 v5, 3, v3
    v_lshlrev_b32 v5, 10, v5
    v_and_b32 v6, 7, v3
    v_lshl_add_u32 v6, v2, 3, v6
    v_lshl_add_u32 v6, v6, 5, v5
    v_lshl_add_u32 v5, v2, 5, v5
    s_lshl_b32 s65, s55, 7
    v_add_u32 v5, s65, v5
    s_waitcnt lgkmcnt(0)
    global_load_dwordx4 v[32:35], v6, s[8:9]
    global_load_dwordx4 v[36:39], v6, s[8:9] offset:16
    global_load_dwordx4 v[40:43], v5, s[8:9]
    global_load_dwordx4 v[44:47], v5, s[8:9] offset:16
    s_mov_b32 s48, s14
    s_mov_b32 s49, s15
    s_mov_b32 s50, 4194304
    s_mov_b32 s51, 0x20000
    s_lshl_b32 s65, s55, 19
    s_lshl_b32 s66, s54, 8
    s_add_u32 s65, s65, s66
    v_lshlrev_b32 v7, 17, v2
    v_lshl_add_u32 v7, v3, 4, v7
    buffer_load_dwordx4 v[176:179], v7, s[48:51], s65 offen nt
    s_add_u32 s65, s65, 8192
    buffer_load_dwordx4 v[180:183], v7, s[48:51], s65 offen nt
    s_add_u32 s65, s65, 8192
    buffer_load_dwordx4 v[184:187], v7, s[48:51], s65 offen nt
    s_add_u32 s65, s65, 8192
    buffer_load_dwordx4 v[188:191], v7, s[48:51], s65 offen nt
    s_add_u32 s65, s65, 8192
    buffer_load_dwordx4 v[192:195], v7, s[48:51], s65 offen nt
    s_add_u32 s65, s65, 8192
    buffer_load_dwordx4 v[196:199], v7, s[48:51], s65 offen nt
    s_add_u32 s65, s65, 8192
    buffer_load_dwordx4 v[200:203], v7, s[48:51], s65 offen nt
    s_add_u32 s65, s65, 8192
    buffer_load_dwordx4 v[204:207], v7, s[48:51], s65 offen nt
    s_add_u32 s65, s65, 8192
    buffer_load_dwordx4 v[208:211], v7, s[48:51], s65 offen nt
    s_add_u32 s65, s65, 8192
    buffer_load_dwordx4 v[212:215], v7, s[48:51], s65 offen nt
    s_add_u32 s65, s65, 8192
    buffer_load_dwordx4 v[216:219], v7, s[48:51], s65 offen nt
    s_add_u32 s65, s65, 8192
    buffer_load_dwordx4 v[220:223], v7, s[48:51], s65 offen nt
    s_add_u32 s65, s65, 8192
    buffer_load_dwordx4 v[224:227], v7, s[48:51], s65 offen nt
    s_add_u32 s65, s65, 8192
    buffer_load_dwordx4 v[228:231], v7, s[48:51], s65 offen nt
    s_add_u32 s65, s65, 8192
    buffer_load_dwordx4 v[232:235], v7, s[48:51], s65 offen nt
    s_add_u32 s65, s65, 8192
    buffer_load_dwordx4 v[236:239], v7, s[48:51], s65 offen nt
    v_mov_b32 v28, 0xff
    s_getreg_b32 s71, hwreg(HW_REG_XCC_ID, 0, 4)
    s_mov_b32 s44, s32
    s_mov_b32 s45, s33
    s_mov_b32 s46, 2097152
    s_mov_b32 s47, 0x20000
    s_xor_b32 s69, s68, 32768
    buffer_load_dwordx4 v[64:67], v4, s[36:39], s69 offen offset:0 nt
    buffer_load_dwordx4 v[68:71], v4, s[36:39], s69 offen offset:2048 nt
    buffer_load_dwordx4 v[72:75], v4, s[36:39], s69 offen offset:1024 nt
    s_load_dword s58, s[32:33], 0
    s_load_dwordx16 s[16:31], s[0:1], 32
    s_barrier
    v_and_b32 v5, 1, v1
    v_lshlrev_b32 v5, 4, v5
    v_mov_b32 v6, 0xffff
    v_lshlrev_b32 v6, v5, v6
    v_bfe_u32 v5, v1, 1, 2
    v_cmp_eq_u32 vcc, 0, v5
    s_nop 1
    v_cndmask_b32 v12, 0, v6, vcc
    v_cmp_eq_u32 vcc, 1, v5
    s_nop 1
    v_cndmask_b32 v13, 0, v6, vcc
    v_cmp_eq_u32 vcc, 2, v5
    s_nop 1
    v_cndmask_b32 v14, 0, v6, vcc
    v_cmp_eq_u32 vcc, 3, v5
    s_nop 1
    v_cndmask_b32 v15, 0, v6, vcc
    v_mov_b32 v5, 0x3f803f80
    s_waitcnt vmcnt(21)
    v_dot2_f32_bf16 v30, v32, v5, 0
    v_dot2_f32_bf16 v31, v32, v32, 0
    v_dot2_f32_bf16 v30, v33, v5, v30
    v_dot2_f32_bf16 v31, v33, v33, v31
    v_dot2_f32_bf16 v30, v34, v5, v30
    v_dot2_f32_bf16 v31, v34, v34, v31
    v_dot2_f32_bf16 v30, v35, v5, v30
    v_dot2_f32_bf16 v31, v35, v35, v31
    v_dot2_f32_bf16 v30, v36, v5, v30
    v_dot2_f32_bf16 v31, v36, v36, v31
    v_dot2_f32_bf16 v30, v37, v5, v30
    v_dot2_f32_bf16 v31, v37, v37, v31
    v_dot2_f32_bf16 v30, v38, v5, v30
    v_dot2_f32_bf16 v31, v38, v38, v31
    v_dot2_f32_bf16 v30, v39, v5, v30
    v_dot2_f32_bf16 v31, v39, v39, v31
    s_nop 2
    v_add_f32_dpp v30, v30, v30 quad_perm:[1,0,3,2] row_mask:0xf bank_mask:0xf
    v_add_f32_dpp v31, v31, v31 quad_perm:[1,0,3,2] row_mask:0xf bank_mask:0xf
    s_nop 0
    v_add_f32_dpp v30, v30, v30 quad_perm:[2,3,0,1] row_mask:0xf bank_mask:0xf
    v_add_f32_dpp v31, v31, v31 quad_perm:[2,3,0,1] row_mask:0xf bank_mask:0xf
    s_nop 0
    v_add_f32_dpp v30, v30, v30 row_half_mirror row_mask:0xf bank_mask:0xf
    v_add_f32_dpp v31, v31, v31 row_half_mirror row_mask:0xf bank_mask:0xf
    s_nop 0
    v_mov_b32 v5, v30
    v_mov_b32 v6, v31
    s_nop 1
    v_permlane16_swap_b32 v30, v5
    v_permlane16_swap_b32 v31, v6
    v_add_f32 v30, v30, v5
    v_add_f32 v31, v31, v6
    v_mov_b32 v5, v30
    v_mov_b32 v6, v31
    s_nop 1
    v_permlane32_swap_b32 v30, v5
    v_permlane32_swap_b32 v31, v6
    v_add_f32 v30, v30, v5
    v_add_f32 v31, v31, v6
    v_mul_f32 v30, 0x3b000000, v30
    v_mul_f32 v31, 0x3b000000, v31
    v_fma_f32 v31, -v30, v30, v31
    v_max_f32 v31, 0, v31
    v_cvt_pk_bf16_f32 v31, v30, v31
    v_lshlrev_b32 v30, 16, v31
    v_and_b32 v31, 0xffff0000, v31
    v_add_f32 v31, 0x3727c5ac, v31
    v_cvt_pk_bf16_f32 v31, v31, v31
    v_lshlrev_b32 v31, 16, v31
    v_sqrt_f32 v31, v31
    s_nop 0
    v_cvt_pk_bf16_f32 v31, v31, v31
    v_lshlrev_b32 v31, 16, v31
    v_rcp_f32 v31, v31
    s_waitcnt vmcnt(19)
    v_lshlrev_b32 v240, 16, v40
    v_and_b32 v241, 0xffff0000, v40
    v_lshlrev_b32 v242, 16, v41
    v_and_b32 v243, 0xffff0000, v41
    v_lshlrev_b32 v244, 16, v42
    v_and_b32 v245, 0xffff0000, v42
    v_lshlrev_b32 v246, 16, v43
    v_and_b32 v247, 0xffff0000, v43
    v_lshlrev_b32 v248, 16, v44
    v_and_b32 v249, 0xffff0000, v44
    v_lshlrev_b32 v250, 16, v45
    v_and_b32 v251, 0xffff0000, v45
    v_lshlrev_b32 v252, 16, v46
    v_and_b32 v253, 0xffff0000, v46
    v_lshlrev_b32 v254, 16, v47
    v_and_b32 v255, 0xffff0000, v47
    v_pk_add_f32 v[240:241], v[240:241], v[30:31] op_sel_hi:[1,0] neg_lo:[0,1] neg_hi:[0,1]
    v_pk_add_f32 v[242:243], v[242:243], v[30:31] op_sel_hi:[1,0] neg_lo:[0,1] neg_hi:[0,1]
    v_pk_add_f32 v[244:245], v[244:245], v[30:31] op_sel_hi:[1,0] neg_lo:[0,1] neg_hi:[0,1]
    v_pk_add_f32 v[246:247], v[246:247], v[30:31] op_sel_hi:[1,0] neg_lo:[0,1] neg_hi:[0,1]
    v_pk_add_f32 v[248:249], v[248:249], v[30:31] op_sel_hi:[1,0] neg_lo:[0,1] neg_hi:[0,1]
    v_pk_add_f32 v[250:251], v[250:251], v[30:31] op_sel_hi:[1,0] neg_lo:[0,1] neg_hi:[0,1]
    v_pk_add_f32 v[252:253], v[252:253], v[30:31] op_sel_hi:[1,0] neg_lo:[0,1] neg_hi:[0,1]
    v_pk_add_f32 v[254:255], v[254:255], v[30:31] op_sel_hi:[1,0] neg_lo:[0,1] neg_hi:[0,1]
    v_cvt_pk_bf16_f32 v32, v240, v241
    v_cvt_pk_bf16_f32 v33, v242, v243
    v_cvt_pk_bf16_f32 v34, v244, v245
    v_cvt_pk_bf16_f32 v35, v246, v247
    v_cvt_pk_bf16_f32 v36, v248, v249
    v_cvt_pk_bf16_f32 v37, v250, v251
    v_cvt_pk_bf16_f32 v38, v252, v253
    v_cvt_pk_bf16_f32 v39, v254, v255
    v_lshlrev_b32 v240, 16, v32
    v_and_b32 v241, 0xffff0000, v32
    v_lshlrev_b32 v242, 16, v33
    v_and_b32 v243, 0xffff0000, v33
    v_lshlrev_b32 v244, 16, v34
    v_and_b32 v245, 0xffff0000, v34
    v_lshlrev_b32 v246, 16, v35
    v_and_b32 v247, 0xffff0000, v35
    v_lshlrev_b32 v248, 16, v36
    v_and_b32 v249, 0xffff0000, v36
    v_lshlrev_b32 v250, 16, v37
    v_and_b32 v251, 0xffff0000, v37
    v_lshlrev_b32 v252, 16, v38
    v_and_b32 v253, 0xffff0000, v38
    v_lshlrev_b32 v254, 16, v39
    v_and_b32 v255, 0xffff0000, v39
    v_pk_mul_f32 v[240:241], v[240:241], v[30:31] op_sel:[0,1]
    v_pk_mul_f32 v[242:243], v[242:243], v[30:31] op_sel:[0,1]
    v_pk_mul_f32 v[244:245], v[244:245], v[30:31] op_sel:[0,1]
    v_pk_mul_f32 v[246:247], v[246:247], v[30:31] op_sel:[0,1]
    v_pk_mul_f32 v[248:249], v[248:249], v[30:31] op_sel:[0,1]
    v_pk_mul_f32 v[250:251], v[250:251], v[30:31] op_sel:[0,1]
    v_pk_mul_f32 v[252:253], v[252:253], v[30:31] op_sel:[0,1]
    v_pk_mul_f32 v[254:255], v[254:255], v[30:31] op_sel:[0,1]
    v_cvt_pk_bf16_f32 v240, v240, v240
    v_cvt_pk_bf16_f32 v241, v241, v241
    v_cvt_pk_bf16_f32 v242, v242, v242
    v_cvt_pk_bf16_f32 v243, v243, v243
    v_cvt_pk_bf16_f32 v244, v244, v244
    v_cvt_pk_bf16_f32 v245, v245, v245
    v_cvt_pk_bf16_f32 v246, v246, v246
    v_cvt_pk_bf16_f32 v247, v247, v247
    v_cvt_pk_bf16_f32 v248, v248, v248
    v_cvt_pk_bf16_f32 v249, v249, v249
    v_cvt_pk_bf16_f32 v250, v250, v250
    v_cvt_pk_bf16_f32 v251, v251, v251
    v_cvt_pk_bf16_f32 v252, v252, v252
    v_cvt_pk_bf16_f32 v253, v253, v253
    v_cvt_pk_bf16_f32 v254, v254, v254
    v_cvt_pk_bf16_f32 v255, v255, v255
    v_and_b32 v112, v12, v240
    v_and_b32 v113, v13, v240
    v_and_b32 v114, v14, v240
    v_and_b32 v115, v15, v240
    v_and_b32 v116, v12, v241
    v_and_b32 v117, v13, v241
    v_and_b32 v118, v14, v241
    v_and_b32 v119, v15, v241
    v_and_b32 v120, v12, v242
    v_and_b32 v121, v13, v242
    v_and_b32 v122, v14, v242
    v_and_b32 v123, v15, v242
    v_and_b32 v124, v12, v243
    v_and_b32 v125, v13, v243
    v_and_b32 v126, v14, v243
    v_and_b32 v127, v15, v243
    v_and_b32 v128, v12, v244
    v_and_b32 v129, v13, v244
    v_and_b32 v130, v14, v244
    v_and_b32 v131, v15, v244
    v_and_b32 v132, v12, v245
    v_and_b32 v133, v13, v245
    v_and_b32 v134, v14, v245
    v_and_b32 v135, v15, v245
    v_and_b32 v136, v12, v246
    v_and_b32 v137, v13, v246
    v_and_b32 v138, v14, v246
    v_and_b32 v139, v15, v246
    v_and_b32 v140, v12, v247
    v_and_b32 v141, v13, v247
    v_and_b32 v142, v14, v247
    v_and_b32 v143, v15, v247
    v_and_b32 v144, v12, v248
    v_and_b32 v145, v13, v248
    v_and_b32 v146, v14, v248
    v_and_b32 v147, v15, v248
    v_and_b32 v148, v12, v249
    v_and_b32 v149, v13, v249
    v_and_b32 v150, v14, v249
    v_and_b32 v151, v15, v249
    v_and_b32 v152, v12, v250
    v_and_b32 v153, v13, v250
    v_and_b32 v154, v14, v250
    v_and_b32 v155, v15, v250
    v_and_b32 v156, v12, v251
    v_and_b32 v157, v13, v251
    v_and_b32 v158, v14, v251
    v_and_b32 v159, v15, v251
    v_and_b32 v160, v12, v252
    v_and_b32 v161, v13, v252
    v_and_b32 v162, v14, v252
    v_and_b32 v163, v15, v252
    v_and_b32 v164, v12, v253
    v_and_b32 v165, v13, v253
    v_and_b32 v166, v14, v253
    v_and_b32 v167, v15, v253
    v_and_b32 v168, v12, v254
    v_and_b32 v169, v13, v254
    v_and_b32 v170, v14, v254
    v_and_b32 v171, v15, v254
    v_and_b32 v172, v12, v255
    v_and_b32 v173, v13, v255
    v_and_b32 v174, v14, v255
    v_and_b32 v175, v15, v255
    s_waitcnt lgkmcnt(0)
    s_mov_b32 s40, s12
    s_mov_b32 s41, s13
    s_mov_b32 s42, 67108864
    s_mov_b32 s43, 0x20000
    s_add_u32 s58, s58, 0x01010101
    s_and_b32 s59, s58, 0xff
    s_bfe_u32 s60, s58, 0x80008
    s_bfe_u32 s61, s58, 0x80010
    s_lshr_b32 s62, s58, 24
    s_lshl_b32 s67, s71, 28
    s_add_u32 s67, s67, s58
    s_waitcnt vmcnt(18)
    v_mfma_f32_16x16x32_bf16 v[16:19], v[112:115], v[176:179], 0
    s_waitcnt vmcnt(17)
    v_mfma_f32_16x16x32_bf16 v[16:19], v[116:119], v[180:183], v[16:19]
    s_waitcnt vmcnt(16)
    v_mfma_f32_16x16x32_bf16 v[16:19], v[120:123], v[184:187], v[16:19]
    s_waitcnt vmcnt(15)
    v_mfma_f32_16x16x32_bf16 v[16:19], v[124:127], v[188:191], v[16:19]
    s_waitcnt vmcnt(14)
    v_mfma_f32_16x16x32_bf16 v[16:19], v[128:131], v[192:195], v[16:19]
    s_waitcnt vmcnt(13)
    v_mfma_f32_16x16x32_bf16 v[16:19], v[132:135], v[196:199], v[16:19]
    s_waitcnt vmcnt(12)
    v_mfma_f32_16x16x32_bf16 v[16:19], v[136:139], v[200:203], v[16:19]
    s_waitcnt vmcnt(11)
    v_mfma_f32_16x16x32_bf16 v[16:19], v[140:143], v[204:207], v[16:19]
    s_waitcnt vmcnt(10)
    v_mfma_f32_16x16x32_bf16 v[16:19], v[144:147], v[208:211], v[16:19]
    s_waitcnt vmcnt(9)
    v_mfma_f32_16x16x32_bf16 v[16:19], v[148:151], v[212:215], v[16:19]
    s_waitcnt vmcnt(8)
    v_mfma_f32_16x16x32_bf16 v[16:19], v[152:155], v[216:219], v[16:19]
    s_waitcnt vmcnt(7)
    v_mfma_f32_16x16x32_bf16 v[16:19], v[156:159], v[220:223], v[16:19]
    s_waitcnt vmcnt(6)
    v_mfma_f32_16x16x32_bf16 v[16:19], v[160:163], v[224:227], v[16:19]
    s_waitcnt vmcnt(5)
    v_mfma_f32_16x16x32_bf16 v[16:19], v[164:167], v[228:231], v[16:19]
    s_waitcnt vmcnt(4)
    v_mfma_f32_16x16x32_bf16 v[16:19], v[168:171], v[232:235], v[16:19]
    s_waitcnt vmcnt(3)
    v_mfma_f32_16x16x32_bf16 v[16:19], v[172:175], v[236:239], v[16:19]
    buffer_load_dwordx4 v[76:79], v4, s[36:39], s69 offen offset:3072 nt
    s_xor_b32 s69, s68, 65536
    buffer_load_dwordx4 v[80:83], v4, s[36:39], s69 offen offset:0 nt
    buffer_load_dwordx4 v[84:87], v4, s[36:39], s69 offen offset:2048 nt
    v_lshrrev_b32 v5, 5, v1
    v_lshlrev_b32 v5, 12, v5
    v_and_b32 v6, 31, v1
    v_lshl_add_u32 v5, v6, 4, v5
    s_lshl_b32 s65, s54, 13
    s_lshl_b32 s66, s55, 9
    s_add_u32 s65, s65, s66
    s_add_u32 s65, s65, 262144
    v_bfi_b32 v16, v28, s59, v16
    v_bfi_b32 v17, v28, s60, v17
    v_bfi_b32 v18, v28, s61, v18
    v_bfi_b32 v19, v28, s62, v19
    buffer_store_dwordx4 v[16:19], v5, s[44:47], s65 offen
    s_branch L_join
L_rest:
    s_cmp_lg_u32 s57, 2
    s_cbranch_scc1 L_noreset
    v_lshlrev_b32 v5, 2, v3
    v_mov_b32 v6, -1
    ds_write_b32 v5, v6 offset:14336
    v_lshlrev_b32 v5, 2, v1
    ds_write_b32 v5, v6 offset:14592
    s_waitcnt lgkmcnt(0)
L_noreset:
    s_load_dword s58, s[32:33], 0
    s_load_dwordx8 s[8:15], s[0:1], 0
    s_load_dwordx16 s[16:31], s[0:1], 32
    v_mov_b32 v28, 0xff
    s_getreg_b32 s71, hwreg(HW_REG_XCC_ID, 0, 4)
    s_mov_b32 s44, s32
    s_mov_b32 s45, s33
    s_mov_b32 s46, 2097152
    s_mov_b32 s47, 0x20000
    v_and_b32 v5, 1, v1
    v_lshlrev_b32 v5, 4, v5
    v_mov_b32 v6, 0xffff
    v_lshlrev_b32 v6, v5, v6
    v_bfe_u32 v5, v1, 1, 2
    v_cmp_eq_u32 vcc, 0, v5
    s_nop 1
    v_cndmask_b32 v12, 0, v6, vcc
    v_cmp_eq_u32 vcc, 1, v5
    s_nop 1
    v_cndmask_b32 v13, 0, v6, vcc
    v_cmp_eq_u32 vcc, 2, v5
    s_nop 1
    v_cndmask_b32 v14, 0, v6, vcc
    v_cmp_eq_u32 vcc, 3, v5
    s_nop 1
    v_cndmask_b32 v15, 0, v6, vcc
    s_waitcnt vmcnt(3)
    s_xor_b32 s69, s68, 32768
    buffer_load_dwordx4 v[64:67], v4, s[36:39], s69 offen offset:0 nt
    s_waitcnt vmcnt(3)
    buffer_load_dwordx4 v[68:71], v4, s[36:39], s69 offen offset:2048 nt
    s_waitcnt vmcnt(3)
    buffer_load_dwordx4 v[72:75], v4, s[36:39], s69 offen offset:1024 nt
    s_barrier
    s_waitcnt lgkmcnt(0)
    s_mov_b32 s40, s12
    s_mov_b32 s41, s13
    s_mov_b32 s42, 67108864
    s_mov_b32 s43, 0x20000
    s_add_u32 s58, s58, 0x01010101
    s_and_b32 s59, s58, 0xff
    s_bfe_u32 s60, s58, 0x80008
    s_bfe_u32 s61, s58, 0x80010
    s_lshr_b32 s62, s58, 24
    s_lshl_b32 s67, s71, 28
    s_add_u32 s67, s67, s58
    s_cmp_lg_u32 s57, 2
    s_cbranch_scc1 L_noxc
    s_lshl_b32 s65, s81, 27
    s_xor_b32 s65, s65, s67
    s_lshl_b32 s66, s70, 2
    s_add_u32 s66, s66, 4096
    v_mov_b32 v6, s65
    s_mov_b64 exec, 1
    buffer_store_dword v6, v1, s[44:47], s66 offen
    s_mov_b64 exec, -1
L_noxc:
    s_waitcnt vmcnt(2)
    buffer_load_dwordx4 v[76:79], v4, s[36:39], s69 offen offset:3072 nt
    s_waitcnt vmcnt(2)
    s_xor_b32 s69, s68, 65536
    buffer_load_dwordx4 v[80:83], v4, s[36:39], s69 offen offset:0 nt
    s_waitcnt vmcnt(2)
    buffer_load_dwordx4 v[84:87], v4, s[36:39], s69 offen offset:2048 nt
L_join:
    v_cmp_gt_u32 vcc, 8, v3
    s_mov_b32 s63, 0
    s_lshl3_add_u32 s65, s70, s57
    s_lshl_b32 s66, s65, 7
    s_add_u32 s66, s66, 262204
    s_load_dwordx2 s[84:85], s[32:33], s66
    s_lshl_b32 s66, s70, 2
    s_add_u32 s66, s66, 4096
    s_load_dword s82, s[32:33], s66
    s_lshl_b32 s65, s65, 4
    s_add_u32 s65, s65, 655360
    s_load_dword s83, s[32:33], s65
    s_sub_u32 s79, s53, 22
    s_lshl_b32 s77, s57, 13
    v_cndmask_b32 v12, 0, v12, vcc
    v_cndmask_b32 v13, 0, v13, vcc
    v_cndmask_b32 v14, 0, v14, vcc
    v_cndmask_b32 v15, 0, v15, vcc
    v_lshlrev_b32 v7, 4, v1
    s_cmp_lt_u32 s70, 22
    s_cbranch_scc1 L_s_f
    s_cmp_lt_u32 s79, 8
    s_cbranch_scc1 L_s_w
    s_waitcnt vmcnt(2)
    buffer_load_dwordx4 v[88:91], v4, s[36:39], s69 offen offset:1024 nt
    s_waitcnt vmcnt(2)
    buffer_load_dwordx4 v[92:95], v4, s[36:39], s69 offen offset:3072 nt
    s_waitcnt vmcnt(2)
    s_xor_b32 s69, s68, 98304
    buffer_load_dwordx4 v[96:99], v4, s[36:39], s69 offen offset:0 nt
    s_waitcnt vmcnt(2)
    buffer_load_dwordx4 v[100:103], v4, s[36:39], s69 offen offset:2048 nt
    s_waitcnt vmcnt(2)
    buffer_load_dwordx4 v[104:107], v4, s[36:39], s69 offen offset:1024 nt
    s_waitcnt vmcnt(2)
    buffer_load_dwordx4 v[108:111], v4, s[36:39], s69 offen offset:3072 nt
    s_cmp_lg_u32 s57, 0
    s_cbranch_scc1 L_xin_skip
    v_and_b32 v5, 31, v1
    v_lshlrev_b32 v5, 2, v5
    s_lshl_b32 s65, s52, 7
    s_add_u32 s65, s65, 4096
    buffer_load_dword v29, v5, s[44:47], s65 offen sc1
L_xin_skip:
    s_waitcnt vmcnt(2)
    s_xor_b32 s69, s68, 131072
    buffer_load_dwordx4 v[112:115], v4, s[36:39], s69 offen offset:0 nt
    s_waitcnt vmcnt(2)
    buffer_load_dwordx4 v[116:119], v4, s[36:39], s69 offen offset:2048 nt
    s_waitcnt vmcnt(2)
    buffer_load_dwordx4 v[120:123], v4, s[36:39], s69 offen offset:1024 nt
    s_cmp_lg_u32 s57, 0
    s_cbranch_scc1 L_xfn_skip
    s_waitcnt vmcnt(3)
    s_xor_b32 s65, s67, 134217728
    v_cmp_eq_u32 vcc, s65, v29
    v_xor_b32 v29, s67, v29
    v_and_b32 v29, 0xf7ffffff, v29
    s_bcnt1_i32_b32 s65, vcc_lo
    v_cmp_ne_u32 vcc, 0, v29
    s_cmp_ge_u32 s65, 15
    s_cselect_b32 s65, 0, 0x2000
    s_cmp_eq_u64 vcc, 0
    s_cselect_b32 s63, 1, 0
    s_or_b32 s65, s65, s63
    v_mov_b32 v5, 14848
    v_mov_b32 v6, s65
    ds_write_b32 v5, v6
    s_cmp_eq_u32 s63, 0
    s_cbranch_scc1 L_qfarn
L_xfn_skip:
    s_waitcnt vmcnt(2)
    buffer_load_dwordx4 v[124:127], v4, s[36:39], s69 offen offset:3072 nt
    s_waitcnt vmcnt(2)
    s_xor_b32 s69, s68, 163840
    buffer_load_dwordx4 v[128:131], v4, s[36:39], s69 offen offset:0 nt
    s_waitcnt vmcnt(2)
    buffer_load_dwordx4 v[132:135], v4, s[36:39], s69 offen offset:2048 nt
    s_cmp_lg_u32 s57, 1
    s_cbranch_scc1 L_qin_skip
    s_lshl_b32 s78, s54, 13
    s_lshl_b32 s66, s56, 10
    s_add_u32 s78, s78, s66
    s_add_u32 s78, s78, 262144
    buffer_load_dwordx4 v[32:35], v7, s[44:47], s78 offen offset:0 sc1
    buffer_load_dwordx4 v[36:39], v7, s[44:47], s78 offen offset:1024 sc1
    buffer_load_dwordx4 v[40:43], v7, s[44:47], s78 offen offset:2048 sc1
    buffer_load_dwordx4 v[44:47], v7, s[44:47], s78 offen offset:3072 sc1
L_qin_skip:
    s_waitcnt vmcnt(2)
    buffer_load_dwordx4 v[136:139], v4, s[36:39], s69 offen offset:1024 nt
    s_waitcnt vmcnt(2)
    buffer_load_dwordx4 v[140:143], v4, s[36:39], s69 offen offset:3072 nt
    s_waitcnt vmcnt(2)
    s_xor_b32 s69, s68, 196608
    buffer_load_dwordx4 v[144:147], v4, s[36:39], s69 offen offset:0 nt
    s_cmp_lg_u32 s57, 1
    s_cbranch_scc1 L_qfn_skip
    s_waitcnt vmcnt(3)
    s_mov_b32 s64, 0x20000
L_qn_chk:
    v_xor_b32 v32, s59, v32
    v_xor_b32 v33, s60, v33
    v_xor_b32 v34, s61, v34
    v_xor_b32 v35, s62, v35
    v_or3_b32 v30, v32, v33, v34
    v_xor_b32 v36, s59, v36
    v_xor_b32 v37, s60, v37
    v_xor_b32 v38, s61, v38
    v_xor_b32 v39, s62, v39
    v_or3_b32 v30, v30, v35, v36
    v_or3_b32 v30, v30, v37, v38
    v_xor_b32 v40, s59, v40
    v_xor_b32 v41, s60, v41
    v_xor_b32 v42, s61, v42
    v_xor_b32 v43, s62, v43
    v_or3_b32 v30, v30, v39, v40
    v_or3_b32 v30, v30, v41, v42
    v_xor_b32 v44, s59, v44
    v_xor_b32 v45, s60, v45
    v_xor_b32 v46, s61, v46
    v_xor_b32 v47, s62, v47
    v_or3_b32 v30, v30, v43, v44
    v_or3_b32 v30, v30, v45, v46
    v_or_b32 v30, v30, v47
    v_cmp_ne_u32_sdwa vcc, v30, 0 src0_sel:BYTE_0 src1_sel:DWORD
    s_cbranch_vccnz L_qn_again
L_qn_ok:
    v_pk_add_f32 v[32:33], v[32:33], v[40:41]
    v_pk_add_f32 v[34:35], v[34:35], v[42:43]
    v_pk_add_f32 v[36:37], v[36:37], v[44:45]
    v_pk_add_f32 v[38:39], v[38:39], v[46:47]
    v_pk_add_f32 v[32:33], v[32:33], v[36:37]
    v_pk_add_f32 v[34:35], v[34:35], v[38:39]
    v_and_b32 v5, 1, v2
    v_lshlrev_b32 v5, 3, v5
    v_permlane32_swap_b32 v32, v34
    v_permlane32_swap_b32 v33, v35
    v_lshl_add_u32 v5, v3, 4, v5
    v_lshrrev_b32 v6, 1, v2
    v_pk_add_f32 v[32:33], v[32:33], v[34:35]
    v_lshl_add_u32 v5, v6, 2, v5
    v_cvt_pk_bf16_f32 v32, v32, v33
    ds_write_b32 v5, v32 offset:14592
L_qfn_skip:
    s_waitcnt vmcnt(2)
    buffer_load_dwordx4 v[148:151], v4, s[36:39], s69 offen offset:2048 nt
    s_waitcnt vmcnt(2)
    buffer_load_dwordx4 v[152:155], v4, s[36:39], s69 offen offset:1024 nt
    s_waitcnt vmcnt(2)
    buffer_load_dwordx4 v[156:159], v4, s[36:39], s69 offen offset:3072 nt
    v_lshlrev_b32 v5, 4, v3
    s_mov_b32 s64, 0x200000
L_qrn_spin:
    ds_read_b128 v[8:11], v5 offset:14592
    s_sub_u32 s64, s64, 1
    s_cbranch_scc1 L_qrn_go
    s_waitcnt lgkmcnt(0)
    v_max3_u32 v6, v8, v9, v10
    v_max_u32 v6, v6, v11
    v_cmp_eq_u32 vcc, -1, v6
    s_cbranch_vccnz L_qrn_spin
L_qrn_go:
    s_waitcnt lgkmcnt(0)
    v_dot2_f32_bf16 v32, v48, v8, 0
    v_dot2_f32_bf16 v33, v52, v8, 0
    v_dot2_f32_bf16 v34, v56, v8, 0
    v_dot2_f32_bf16 v35, v60, v8, 0
    v_dot2_f32_bf16 v32, v49, v9, v32
    v_dot2_f32_bf16 v33, v53, v9, v33
    v_dot2_f32_bf16 v34, v57, v9, v34
    v_dot2_f32_bf16 v35, v61, v9, v35
    v_dot2_f32_bf16 v32, v50, v10, v32
    v_dot2_f32_bf16 v33, v54, v10, v33
    v_dot2_f32_bf16 v34, v58, v10, v34
    v_dot2_f32_bf16 v35, v62, v10, v35
    v_dot2_f32_bf16 v32, v51, v11, v32
    v_dot2_f32_bf16 v33, v55, v11, v33
    v_dot2_f32_bf16 v34, v59, v11, v34
    v_dot2_f32_bf16 v35, v63, v11, v35
    v_add_f32_dpp v36, v32, v32 row_ror:8 row_mask:0xf bank_mask:0x3
    v_add_f32_dpp v36, v33, v33 row_ror:8 row_mask:0xf bank_mask:0xc
    v_add_f32_dpp v37, v34, v34 row_ror:8 row_mask:0xf bank_mask:0x3
    v_add_f32_dpp v37, v35, v35 row_ror:8 row_mask:0xf bank_mask:0xc
    v_add_f32_dpp v20, v36, v36 row_shl:4 row_mask:0xf bank_mask:0x5
    s_nop 0
    v_add_f32_dpp v20, v37, v37 row_shr:4 row_mask:0xf bank_mask:0xa
    v_dot2_f32_bf16 v32, v64, v8, 0
    v_dot2_f32_bf16 v33, v68, v8, 0
    v_dot2_f32_bf16 v34, v72, v8, 0
    v_dot2_f32_bf16 v35, v76, v8, 0
    v_dot2_f32_bf16 v32, v65, v9, v32
    v_dot2_f32_bf16 v33, v69, v9, v33
    v_dot2_f32_bf16 v34, v73, v9, v34
    v_dot2_f32_bf16 v35, v77, v9, v35
    v_dot2_f32_bf16 v32, v66, v10, v32
    v_dot2_f32_bf16 v33, v70, v10, v33
    v_dot2_f32_bf16 v34, v74, v10, v34
    v_dot2_f32_bf16 v35, v78, v10, v35
    v_dot2_f32_bf16 v32, v67, v11, v32
    v_dot2_f32_bf16 v33, v71, v11, v33
    v_dot2_f32_bf16 v34, v75, v11, v34
    v_dot2_f32_bf16 v35, v79, v11, v35
    v_add_f32_dpp v36, v32, v32 row_ror:8 row_mask:0xf bank_mask:0x3
    v_add_f32_dpp v36, v33, v33 row_ror:8 row_mask:0xf bank_mask:0xc
    v_add_f32_dpp v37, v34, v34 row_ror:8 row_mask:0xf bank_mask:0x3
    v_add_f32_dpp v37, v35, v35 row_ror:8 row_mask:0xf bank_mask:0xc
    v_add_f32_dpp v21, v36, v36 row_shl:4 row_mask:0xf bank_mask:0x5
    s_nop 0
    v_add_f32_dpp v21, v37, v37 row_shr:4 row_mask:0xf bank_mask:0xa
    v_dot2_f32_bf16 v32, v80, v8, 0
    v_dot2_f32_bf16 v33, v84, v8, 0
    v_dot2_f32_bf16 v34, v88, v8, 0
    v_dot2_f32_bf16 v35, v92, v8, 0
    v_dot2_f32_bf16 v32, v81, v9, v32
    v_dot2_f32_bf16 v33, v85, v9, v33
    v_dot2_f32_bf16 v34, v89, v9, v34
    v_dot2_f32_bf16 v35, v93, v9, v35
    v_dot2_f32_bf16 v32, v82, v10, v32
    v_dot2_f32_bf16 v33, v86, v10, v33
    v_dot2_f32_bf16 v34, v90, v10, v34
    v_dot2_f32_bf16 v35, v94, v10, v35
    v_dot2_f32_bf16 v32, v83, v11, v32
    v_dot2_f32_bf16 v33, v87, v11, v33
    v_dot2_f32_bf16 v34, v91, v11, v34
    v_dot2_f32_bf16 v35, v95, v11, v35
    v_add_f32_dpp v36, v32, v32 row_ror:8 row_mask:0xf bank_mask:0x3
    v_add_f32_dpp v36, v33, v33 row_ror:8 row_mask:0xf bank_mask:0xc
    v_add_f32_dpp v37, v34, v34 row_ror:8 row_mask:0xf bank_mask:0x3
    v_add_f32_dpp v37, v35, v35 row_ror:8 row_mask:0xf bank_mask:0xc
    v_add_f32_dpp v22, v36, v36 row_shl:4 row_mask:0xf bank_mask:0x5
    s_nop 0
    v_add_f32_dpp v22, v37, v37 row_shr:4 row_mask:0xf bank_mask:0xa
    v_dot2_f32_bf16 v32, v96, v8, 0
    v_dot2_f32_bf16 v33, v100, v8, 0
    v_dot2_f32_bf16 v34, v104, v8, 0
    v_dot2_f32_bf16 v35, v108, v8, 0
    v_dot2_f32_bf16 v32, v97, v9, v32
    v_dot2_f32_bf16 v33, v101, v9, v33
    v_dot2_f32_bf16 v34, v105, v9, v34
    v_dot2_f32_bf16 v35, v109, v9, v35
    v_dot2_f32_bf16 v32, v98, v10, v32
    v_dot2_f32_bf16 v33, v102, v10, v33
    v_dot2_f32_bf16 v34, v106, v10, v34
    v_dot2_f32_bf16 v35, v110, v10, v35
    v_dot2_f32_bf16 v32, v99, v11, v32
    v_dot2_f32_bf16 v33, v103, v11, v33
    v_dot2_f32_bf16 v34, v107, v11, v34
    v_dot2_f32_bf16 v35, v111, v11, v35
    v_add_f32_dpp v36, v32, v32 row_ror:8 row_mask:0xf bank_mask:0x3
    v_add_f32_dpp v36, v33, v33 row_ror:8 row_mask:0xf bank_mask:0xc
    v_add_f32_dpp v37, v34, v34 row_ror:8 row_mask:0xf bank_mask:0x3
    v_add_f32_dpp v37, v35, v35 row_ror:8 row_mask:0xf bank_mask:0xc
    v_add_f32_dpp v23, v36, v36 row_shl:4 row_mask:0xf bank_mask:0x5
    s_nop 0
    v_add_f32_dpp v23, v37, v37 row_shr:4 row_mask:0xf bank_mask:0xa
    v_dot2_f32_bf16 v32, v112, v8, 0
    v_dot2_f32_bf16 v33, v116, v8, 0
    v_dot2_f32_bf16 v34, v120, v8, 0
    v_dot2_f32_bf16 v35, v124, v8, 0
    v_dot2_f32_bf16 v32, v113, v9, v32
    v_dot2_f32_bf16 v33, v117, v9, v33
    v_dot2_f32_bf16 v34, v121, v9, v34
    v_dot2_f32_bf16 v35, v125, v9, v35
    v_dot2_f32_bf16 v32, v114, v10, v32
    v_dot2_f32_bf16 v33, v118, v10, v33
    v_dot2_f32_bf16 v34, v122, v10, v34
    v_dot2_f32_bf16 v35, v126, v10, v35
    v_dot2_f32_bf16 v32, v115, v11, v32
    v_dot2_f32_bf16 v33, v119, v11, v33
    v_dot2_f32_bf16 v34, v123, v11, v34
    v_dot2_f32_bf16 v35, v127, v11, v35
    v_add_f32_dpp v36, v32, v32 row_ror:8 row_mask:0xf bank_mask:0x3
    v_add_f32_dpp v36, v33, v33 row_ror:8 row_mask:0xf bank_mask:0xc
    v_add_f32_dpp v37, v34, v34 row_ror:8 row_mask:0xf bank_mask:0x3
    v_add_f32_dpp v37, v35, v35 row_ror:8 row_mask:0xf bank_mask:0xc
    v_add_f32_dpp v24, v36, v36 row_shl:4 row_mask:0xf bank_mask:0x5
    s_nop 0
    v_add_f32_dpp v24, v37, v37 row_shr:4 row_mask:0xf bank_mask:0xa
    s_waitcnt vmcnt(2)
    s_xor_b32 s69, s68, 229376
    buffer_load_dwordx4 v[160:163], v4, s[36:39], s69 offen offset:0 nt
    s_waitcnt vmcnt(2)
    buffer_load_dwordx4 v[164:167], v4, s[36:39], s69 offen offset:2048 nt
    s_waitcnt vmcnt(2)
    buffer_load_dwordx4 v[168:171], v4, s[36:39], s69 offen offset:1024 nt
    v_dot2_f32_bf16 v32, v128, v8, 0
    v_dot2_f32_bf16 v33, v132, v8, 0
    v_dot2_f32_bf16 v34, v136, v8, 0
    v_dot2_f32_bf16 v35, v140, v8, 0
    v_dot2_f32_bf16 v32, v129, v9, v32
    v_dot2_f32_bf16 v33, v133, v9, v33
    v_dot2_f32_bf16 v34, v137, v9, v34
    v_dot2_f32_bf16 v35, v141, v9, v35
    v_dot2_f32_bf16 v32, v130, v10, v32
    v_dot2_f32_bf16 v33, v134, v10, v33
    v_dot2_f32_bf16 v34, v138, v10, v34
    v_dot2_f32_bf16 v35, v142, v10, v35
    v_dot2_f32_bf16 v32, v131, v11, v32
    v_dot2_f32_bf16 v33, v135, v11, v33
    v_dot2_f32_bf16 v34, v139, v11, v34
    v_dot2_f32_bf16 v35, v143, v11, v35
    v_add_f32_dpp v36, v32, v32 row_ror:8 row_mask:0xf bank_mask:0x3
    v_add_f32_dpp v36, v33, v33 row_ror:8 row_mask:0xf bank_mask:0xc
    v_add_f32_dpp v37, v34, v34 row_ror:8 row_mask:0xf bank_mask:0x3
    v_add_f32_dpp v37, v35, v35 row_ror:8 row_mask:0xf bank_mask:0xc
    v_add_f32_dpp v25, v36, v36 row_shl:4 row_mask:0xf bank_mask:0x5
    s_nop 0
    v_add_f32_dpp v25, v37, v37 row_shr:4 row_mask:0xf bank_mask:0xa
    v_dot2_f32_bf16 v32, v144, v8, 0
    v_dot2_f32_bf16 v33, v148, v8, 0
    v_dot2_f32_bf16 v34, v152, v8, 0
    v_dot2_f32_bf16 v35, v156, v8, 0
    v_dot2_f32_bf16 v32, v145, v9, v32
    v_dot2_f32_bf16 v33, v149, v9, v33
    v_dot2_f32_bf16 v34, v153, v9, v34
    v_dot2_f32_bf16 v35, v157, v9, v35
    v_dot2_f32_bf16 v32, v146, v10, v32
    v_dot2_f32_bf16 v33, v150, v10, v33
    v_dot2_f32_bf16 v34, v154, v10, v34
    v_dot2_f32_bf16 v35, v158, v10, v35
    v_dot2_f32_bf16 v32, v147, v11, v32
    v_dot2_f32_bf16 v33, v151, v11, v33
    v_dot2_f32_bf16 v34, v155, v11, v34
    v_dot2_f32_bf16 v35, v159, v11, v35
    v_add_f32_dpp v36, v32, v32 row_ror:8 row_mask:0xf bank_mask:0x3
    v_add_f32_dpp v36, v33, v33 row_ror:8 row_mask:0xf bank_mask:0xc
    v_add_f32_dpp v37, v34, v34 row_ror:8 row_mask:0xf bank_mask:0x3
    v_add_f32_dpp v37, v35, v35 row_ror:8 row_mask:0xf bank_mask:0xc
    v_add_f32_dpp v26, v36, v36 row_shl:4 row_mask:0xf bank_mask:0x5
    s_nop 0
    v_add_f32_dpp v26, v37, v37 row_shr:4 row_mask:0xf bank_mask:0xa
    s_waitcnt vmcnt(2)
    buffer_load_dwordx4 v[172:175], v4, s[36:39], s69 offen offset:3072 nt
    s_waitcnt vmcnt(2)
    buffer_load_dwordx4 v[176:179], v4, s[40:43], s68 offen offset:0 nt
    s_waitcnt vmcnt(2)
    buffer_load_dwordx4 v[180:183], v4, s[40:43], s68 offen offset:2048 nt
    s_waitcnt vmcnt(2)
    buffer_load_dwordx4 v[184:187], v4, s[40:43], s68 offen offset:1024 nt
    s_waitcnt vmcnt(2)
    buffer_load_dwordx4 v[188:191], v4, s[40:43], s68 offen offset:3072 nt
    s_waitcnt vmcnt(2)
    s_xor_b32 s69, s68, 32768
    buffer_load_dwordx4 v[192:195], v4, s[40:43], s69 offen offset:0 nt
    v_dot2_f32_bf16 v32, v160, v8, 0
    v_dot2_f32_bf16 v33, v164, v8, 0
    v_dot2_f32_bf16 v34, v168, v8, 0
    v_dot2_f32_bf16 v35, v172, v8, 0
    v_dot2_f32_bf16 v32, v161, v9, v32
    v_dot2_f32_bf16 v33, v165, v9, v33
    v_dot2_f32_bf16 v34, v169, v9, v34
    v_dot2_f32_bf16 v35, v173, v9, v35
    v_dot2_f32_bf16 v32, v162, v10, v32
    v_dot2_f32_bf16 v33, v166, v10, v33
    v_dot2_f32_bf16 v34, v170, v10, v34
    v_dot2_f32_bf16 v35, v174, v10, v35
    v_dot2_f32_bf16 v32, v163, v11, v32
    v_dot2_f32_bf16 v33, v167, v11, v33
    v_dot2_f32_bf16 v34, v171, v11, v34
    v_dot2_f32_bf16 v35, v175, v11, v35
    v_add_f32_dpp v36, v32, v32 row_ror:8 row_mask:0xf bank_mask:0x3
    v_add_f32_dpp v36, v33, v33 row_ror:8 row_mask:0xf bank_mask:0xc
    v_add_f32_dpp v37, v34, v34 row_ror:8 row_mask:0xf bank_mask:0x3
    v_add_f32_dpp v37, v35, v35 row_ror:8 row_mask:0xf bank_mask:0xc
    v_add_f32_dpp v27, v36, v36 row_shl:4 row_mask:0xf bank_mask:0x5
    s_nop 0
    v_add_f32_dpp v27, v37, v37 row_shr:4 row_mask:0xf bank_mask:0xa
    v_add_f32_dpp v20, v20, v20 quad_perm:[1,0,3,2] row_mask:0xf bank_mask:0xf
    v_add_f32_dpp v21, v21, v21 quad_perm:[1,0,3,2] row_mask:0xf bank_mask:0xf
    v_add_f32_dpp v22, v22, v22 quad_perm:[1,0,3,2] row_mask:0xf bank_mask:0xf
    v_add_f32_dpp v23, v23, v23 quad_perm:[1,0,3,2] row_mask:0xf bank_mask:0xf
    v_add_f32_dpp v24, v24, v24 quad_perm:[1,0,3,2] row_mask:0xf bank_mask:0xf
    v_add_f32_dpp v25, v25, v25 quad_perm:[1,0,3,2] row_mask:0xf bank_mask:0xf
    v_add_f32_dpp v26, v26, v26 quad_perm:[1,0,3,2] row_mask:0xf bank_mask:0xf
    v_add_f32_dpp v27, v27, v27 quad_perm:[1,0,3,2] row_mask:0xf bank_mask:0xf
    v_add_f32_dpp v20, v20, v20 quad_perm:[2,3,0,1] row_mask:0xf bank_mask:0xf
    v_add_f32_dpp v21, v21, v21 quad_perm:[2,3,0,1] row_mask:0xf bank_mask:0xf
    v_add_f32_dpp v22, v22, v22 quad_perm:[2,3,0,1] row_mask:0xf bank_mask:0xf
    v_add_f32_dpp v23, v23, v23 quad_perm:[2,3,0,1] row_mask:0xf bank_mask:0xf
    v_add_f32_dpp v24, v24, v24 quad_perm:[2,3,0,1] row_mask:0xf bank_mask:0xf
    v_add_f32_dpp v25, v25, v25 quad_perm:[2,3,0,1] row_mask:0xf bank_mask:0xf
    v_add_f32_dpp v26, v26, v26 quad_perm:[2,3,0,1] row_mask:0xf bank_mask:0xf
    v_add_f32_dpp v27, v27, v27 quad_perm:[2,3,0,1] row_mask:0xf bank_mask:0xf
    v_cvt_pk_bf16_f32 v32, v20, v21
    v_cvt_pk_bf16_f32 v33, v22, v23
    v_cvt_pk_bf16_f32 v34, v24, v25
    v_cvt_pk_bf16_f32 v35, v26, v27
    v_lshlrev_b32 v20, 16, v32
    v_and_b32 v21, 0xffff0000, v32
    v_lshlrev_b32 v22, 16, v33
    v_and_b32 v23, 0xffff0000, v33
    v_lshlrev_b32 v24, 16, v34
    v_and_b32 v25, 0xffff0000, v34
    v_lshlrev_b32 v26, 16, v35
    v_and_b32 v27, 0xffff0000, v35
    v_mul_f32 v20, 0x3db504f3, v20
    v_mul_f32 v21, 0x3db504f3, v21
    v_mul_f32 v22, 0x3db504f3, v22
    v_mul_f32 v23, 0x3db504f3, v23
    v_mul_f32 v24, 0x3db504f3, v24
    v_mul_f32 v25, 0x3db504f3, v25
    v_mul_f32 v26, 0x3db504f3, v26
    v_mul_f32 v27, 0x3db504f3, v27
    v_cvt_pk_bf16_f32 v32, v20, v21
    v_cvt_pk_bf16_f32 v33, v22, v23
    v_cvt_pk_bf16_f32 v34, v24, v25
    v_cvt_pk_bf16_f32 v35, v26, v27
    v_lshlrev_b32 v20, 16, v32
    v_and_b32 v21, 0xffff0000, v32
    v_lshlrev_b32 v22, 16, v33
    v_and_b32 v23, 0xffff0000, v33
    v_lshlrev_b32 v24, 16, v34
    v_and_b32 v25, 0xffff0000, v34
    v_lshlrev_b32 v26, 16, v35
    v_and_b32 v27, 0xffff0000, v35
    v_max3_f32 v30, v20, v21, v22
    v_max3_f32 v30, v30, v23, v24
    v_max3_f32 v30, v30, v25, v26
    v_max_f32 v30, v30, v27
    s_nop 1
    v_max_f32_dpp v30, v30, v30 row_ror:8 row_mask:0xf bank_mask:0xf
    s_nop 1
    v_max_f32_dpp v30, v30, v30 row_ror:4 row_mask:0xf bank_mask:0xf
    v_mov_b32 v32, v30
    s_nop 1
    v_permlane16_swap_b32 v30, v32
    v_max_f32 v30, v30, v32
    v_mov_b32 v32, v30
    s_nop 1
    v_permlane32_swap_b32 v30, v32
    v_max_f32 v30, v30, v32
    v_sub_f32 v20, v20, v30
    v_sub_f32 v21, v21, v30
    v_sub_f32 v22, v22, v30
    v_sub_f32 v23, v23, v30
    v_sub_f32 v24, v24, v30
    v_sub_f32 v25, v25, v30
    v_sub_f32 v26, v26, v30
    v_sub_f32 v27, v27, v30
    v_mul_f32 v20, 0x3fb8aa3b, v20
    v_mul_f32 v21, 0x3fb8aa3b, v21
    v_mul_f32 v22, 0x3fb8aa3b, v22
    v_mul_f32 v23, 0x3fb8aa3b, v23
    v_mul_f32 v24, 0x3fb8aa3b, v24
    v_mul_f32 v25, 0x3fb8aa3b, v25
    v_mul_f32 v26, 0x3fb8aa3b, v26
    v_mul_f32 v27, 0x3fb8aa3b, v27
    v_exp_f32 v20, v20
    v_exp_f32 v21, v21
    v_exp_f32 v22, v22
    v_exp_f32 v23, v23
    v_exp_f32 v24, v24
    v_exp_f32 v25, v25
    v_exp_f32 v26, v26
    v_exp_f32 v27, v27
    s_waitcnt vmcnt(2)
    buffer_load_dwordx4 v[196:199], v4, s[40:43], s69 offen offset:2048 nt
    s_waitcnt vmcnt(2)
    buffer_load_dwordx4 v[200:203], v4, s[40:43], s69 offen offset:1024 nt
    s_waitcnt vmcnt(2)
    buffer_load_dwordx4 v[204:207], v4, s[40:43], s69 offen offset:3072 nt
    s_lshl_b32 s65, s57, 3
    v_add_f32 v31, v20, v21
    v_add_f32 v31, v31, v22
    v_add_f32 v31, v31, v23
    v_add_f32 v31, v31, v24
    v_add_f32 v31, v31, v25
    v_add_f32 v31, v31, v26
    v_add_f32 v31, v31, v27
    v_cvt_pk_bf16_f32 v20, v20, v20
    v_cvt_pk_bf16_f32 v21, v21, v21
    v_cvt_pk_bf16_f32 v22, v22, v22
    v_cvt_pk_bf16_f32 v23, v23, v23
    v_cvt_pk_bf16_f32 v24, v24, v24
    v_cvt_pk_bf16_f32 v25, v25, v25
    v_cvt_pk_bf16_f32 v26, v26, v26
    v_cvt_pk_bf16_f32 v27, v27, v27
    s_nop 1
    v_add_f32_dpp v31, v31, v31 row_ror:8 row_mask:0xf bank_mask:0xf
    s_nop 1
    v_add_f32_dpp v31, v31, v31 row_ror:4 row_mask:0xf bank_mask:0xf
    v_mov_b32 v32, v31
    s_nop 1
    v_permlane16_swap_b32 v31, v32
    v_add_f32 v31, v31, v32
    v_mov_b32 v32, v31
    s_nop 1
    v_permlane32_swap_b32 v31, v32
    v_add_f32 v31, v31, v32
    v_mov_b32 v5, s65
    ds_write_b64 v5, v[30:31] offset:14336
    v_bfe_u32 v6, v1, 3, 1
    v_bfe_u32 v147, v1, 2, 1
    v_and_b32 v7, 3, v1
    v_lshlrev_b32 v133, 3, v1
    v_lshlrev_b32 v166, 4, v1
    v_and_b32 v154, 0x70, v166
    v_lshl_add_u32 v29, v7, 1, v6
    v_and_b32 v5, 1, v2
    v_lshl_add_u32 v29, v5, 3, v29
    v_lshrrev_b32 v5, 1, v2
    v_lshl_add_u32 v29, v5, 5, v29
    v_lshlrev_b32 v134, 1, v29
    v_lshl_add_u32 v122, v147, 10, v134
    s_lshl_b32 s65, s57, 7
    v_add_u32 v122, s65, v122
    v_lshl_add_u32 v29, v147, 4, v29
    v_lshlrev_b32 v167, 3, v29
    s_lshl_b32 s65, s57, 8
    v_lshl_add_u32 v155, v29, 2, s65
    s_lshr_b32 s65, s53, 3
    s_and_b32 s66, s53, 4
    s_add_u32 s65, s65, s66
    s_and_b32 s66, s53, 3
    s_lshl3_add_u32 s66, s65, s66
    s_lshl_b32 s66, s66, 5
    v_and_b32 v29, 7, v1
    v_lshl_add_u32 v123, v5, 5, v29
    v_lshl_add_u32 v123, v123, 2, s66
    v_and_b32 v5, 1, v2
    v_lshl_add_u32 v123, v5, 1, v123
    s_and_b32 s66, s53, 1
    s_lshl3_add_u32 s65, s65, s66
    s_lshl_b32 s65, s65, 4
    s_and_b32 s66, s53, 2
    s_lshl_b32 s66, s66, 9
    s_add_u32 s65, s65, s66
    v_lshl_add_u32 v141, v2, 4, v29
    v_lshl_add_u32 v141, v141, 1, s65
    v_lshlrev_b32 v135, 4, v3
    v_lshl_add_u32 v135, v2, 10, v135
    s_and_b32 s65, s57, 6
    s_add_u32 s65, s65, s57
    s_lshl_b32 s65, s65, 12
    s_add_u32 s65, s65, 65536
    v_add_u32 v135, s65, v135
    s_lshl_b32 s65, s57, 9
    v_lshlrev_b32 v146, 5, v3
    v_lshl_add_u32 v146, v2, 4, v146
    v_add_u32 v146, s65, v146
    s_lshl2_add_u32 s66, s54, 0
    s_lshl1_add_u32 s66, s66, s56
    s_lshl1_add_u32 s66, s66, s55
    s_lshl_b32 s66, s66, 9
    s_add_u32 s66, s66, 262144
    v_add_u32 v128, s66, v133
    s_xor_b32 s66, s58, 0x80808080
    v_and_b32 v29, 1, v1
    v_lshlrev_b32 v29, 4, v29
    v_lshrrev_b32 v131, v29, s66
    v_and_b32 v130, v28, v131
    v_bfe_u32 v131, v131, 8, 8
    v_and_b32_dpp v32, v20, v12 row_newbcast:0 row_mask:0xf bank_mask:0xf
    v_and_b32_dpp v33, v20, v13 row_newbcast:0 row_mask:0xf bank_mask:0xf
    v_and_b32_dpp v34, v20, v14 row_newbcast:0 row_mask:0xf bank_mask:0xf
    v_and_b32_dpp v35, v20, v15 row_newbcast:0 row_mask:0xf bank_mask:0xf
    v_and_b32_dpp v36, v20, v12 row_newbcast:8 row_mask:0xf bank_mask:0xf
    v_and_b32_dpp v37, v20, v13 row_newbcast:8 row_mask:0xf bank_mask:0xf
    v_and_b32_dpp v38, v20, v14 row_newbcast:8 row_mask:0xf bank_mask:0xf
    v_and_b32_dpp v39, v20, v15 row_newbcast:8 row_mask:0xf bank_mask:0xf
    v_and_b32_dpp v40, v20, v12 row_newbcast:4 row_mask:0xf bank_mask:0xf
    v_and_b32_dpp v41, v20, v13 row_newbcast:4 row_mask:0xf bank_mask:0xf
    v_and_b32_dpp v42, v20, v14 row_newbcast:4 row_mask:0xf bank_mask:0xf
    v_and_b32_dpp v43, v20, v15 row_newbcast:4 row_mask:0xf bank_mask:0xf
    v_and_b32_dpp v44, v20, v12 row_newbcast:12 row_mask:0xf bank_mask:0xf
    v_and_b32_dpp v45, v20, v13 row_newbcast:12 row_mask:0xf bank_mask:0xf
    v_and_b32_dpp v46, v20, v14 row_newbcast:12 row_mask:0xf bank_mask:0xf
    v_and_b32_dpp v47, v20, v15 row_newbcast:12 row_mask:0xf bank_mask:0xf
    v_mfma_f32_16x16x32_bf16 v[16:19], v[32:35], v[176:179], 0
    v_mfma_f32_16x16x32_bf16 v[16:19], v[36:39], v[180:183], v[16:19]
    v_mfma_f32_16x16x32_bf16 v[16:19], v[40:43], v[184:187], v[16:19]
    v_mfma_f32_16x16x32_bf16 v[16:19], v[44:47], v[188:191], v[16:19]
    s_waitcnt vmcnt(2)
    s_xor_b32 s69, s68, 65536
    buffer_load_dwordx4 v[208:211], v4, s[40:43], s69 offen offset:0 nt
    s_waitcnt vmcnt(2)
    buffer_load_dwordx4 v[212:215], v4, s[40:43], s69 offen offset:2048 nt
    s_waitcnt vmcnt(2)
    buffer_load_dwordx4 v[216:219], v4, s[40:43], s69 offen offset:1024 nt
    s_cmp_lg_u32 s57, 0
    s_cbranch_scc1 L_mpn_skip
    v_and_b32 v5, 56, v133
    s_mov_b32 s64, 0x200000
L_mln_spin:
    ds_read_b64 v[152:153], v5 offset:14336
    s_sub_u32 s64, s64, 1
    s_cbranch_scc1 L_mln_go
    s_waitcnt lgkmcnt(0)
    v_cmp_eq_u32 vcc, -1, v153
    s_cbranch_vccnz L_mln_spin
L_mln_go:
    s_waitcnt lgkmcnt(0)
    s_nop 1
    v_max_f32_dpp v148, v152, v152 quad_perm:[1,0,3,2] row_mask:0xf bank_mask:0xf
    s_nop 1
    v_max_f32_dpp v148, v148, v148 quad_perm:[2,3,0,1] row_mask:0xf bank_mask:0xf
    s_nop 1
    v_max_f32_dpp v148, v148, v148 row_half_mirror row_mask:0xf bank_mask:0xf
    v_sub_f32 v149, v152, v148
    v_mul_f32 v149, 0x3fb8aa3b, v149
    v_exp_f32 v149, v149
    v_mov_b32 v150, 0
    v_mul_f32 v149, v149, v153
    v_mov_b32 v151, 0
    s_lshl_b32 s65, s70, 7
    v_add_f32_dpp v149, v149, v149 quad_perm:[1,0,3,2] row_mask:0xf bank_mask:0xf
    s_nop 1
    v_add_f32_dpp v149, v149, v149 quad_perm:[2,3,0,1] row_mask:0xf bank_mask:0xf
    s_nop 1
    v_add_f32_dpp v149, v149, v149 row_half_mirror row_mask:0xf bank_mask:0xf
    s_nop 1
    s_add_u32 s65, s65, 655360
    v_bfi_b32 v148, v28, s59, v148
    v_bfi_b32 v149, v28, s60, v149
    v_bfi_b32 v150, v28, s61, v150
    v_bfi_b32 v151, v28, s62, v151
    s_mov_b64 exec, 0xff
    s_cmp_eq_u32 s63, 0
    s_cbranch_scc1 L_mln_alt
    buffer_store_dwordx4 v[148:151], v166, s[44:47], s65 offen
    s_branch L_mln_pub
L_mln_alt:
    buffer_store_dwordx4 v[148:151], v166, s[44:47], s65 offen sc1
L_mln_pub:
    s_mov_b64 exec, -1
L_mpn_skip:
    v_and_b32_dpp v32, v21, v12 row_newbcast:0 row_mask:0xf bank_mask:0xf
    v_and_b32_dpp v33, v21, v13 row_newbcast:0 row_mask:0xf bank_mask:0xf
    v_and_b32_dpp v34, v21, v14 row_newbcast:0 row_mask:0xf bank_mask:0xf
    v_and_b32_dpp v35, v21, v15 row_newbcast:0 row_mask:0xf bank_mask:0xf
    v_and_b32_dpp v36, v21, v12 row_newbcast:8 row_mask:0xf bank_mask:0xf
    v_and_b32_dpp v37, v21, v13 row_newbcast:8 row_mask:0xf bank_mask:0xf
    v_and_b32_dpp v38, v21, v14 row_newbcast:8 row_mask:0xf bank_mask:0xf
    v_and_b32_dpp v39, v21, v15 row_newbcast:8 row_mask:0xf bank_mask:0xf
    v_and_b32_dpp v40, v21, v12 row_newbcast:4 row_mask:0xf bank_mask:0xf
    v_and_b32_dpp v41, v21, v13 row_newbcast:4 row_mask:0xf bank_mask:0xf
    v_and_b32_dpp v42, v21, v14 row_newbcast:4 row_mask:0xf bank_mask:0xf
    v_and_b32_dpp v43, v21, v15 row_newbcast:4 row_mask:0xf bank_mask:0xf
    v_and_b32_dpp v44, v21, v12 row_newbcast:12 row_mask:0xf bank_mask:0xf
    v_and_b32_dpp v45, v21, v13 row_newbcast:12 row_mask:0xf bank_mask:0xf
    v_and_b32_dpp v46, v21, v14 row_newbcast:12 row_mask:0xf bank_mask:0xf
    v_and_b32_dpp v47, v21, v15 row_newbcast:12 row_mask:0xf bank_mask:0xf
    v_mfma_f32_16x16x32_bf16 v[16:19], v[32:35], v[192:195], v[16:19]
    v_mfma_f32_16x16x32_bf16 v[16:19], v[36:39], v[196:199], v[16:19]
    v_mfma_f32_16x16x32_bf16 v[16:19], v[40:43], v[200:203], v[16:19]
    v_mfma_f32_16x16x32_bf16 v[16:19], v[44:47], v[204:207], v[16:19]
    s_waitcnt vmcnt(2)
    buffer_load_dwordx4 v[220:223], v4, s[40:43], s69 offen offset:3072 nt
    s_waitcnt vmcnt(2)
    s_xor_b32 s69, s68, 98304
    buffer_load_dwordx4 v[224:227], v4, s[40:43], s69 offen offset:0 nt
    s_waitcnt vmcnt(2)
    buffer_load_dwordx4 v[228:231], v4, s[40:43], s69 offen offset:2048 nt
    s_waitcnt vmcnt(2)
    buffer_load_dwordx4 v[232:235], v4, s[40:43], s69 offen offset:1024 nt
    s_waitcnt vmcnt(2)
    buffer_load_dwordx4 v[236:239], v4, s[40:43], s69 offen offset:3072 nt
    s_waitcnt vmcnt(2)
    s_xor_b32 s69, s68, 131072
    buffer_load_dwordx4 v[240:243], v4, s[40:43], s69 offen offset:0 nt
    v_and_b32_dpp v32, v22, v12 row_newbcast:0 row_mask:0xf bank_mask:0xf
    v_and_b32_dpp v33, v22, v13 row_newbcast:0 row_mask:0xf bank_mask:0xf
    v_and_b32_dpp v34, v22, v14 row_newbcast:0 row_mask:0xf bank_mask:0xf
    v_and_b32_dpp v35, v22, v15 row_newbcast:0 row_mask:0xf bank_mask:0xf
    v_and_b32_dpp v36, v22, v12 row_newbcast:8 row_mask:0xf bank_mask:0xf
    v_and_b32_dpp v37, v22, v13 row_newbcast:8 row_mask:0xf bank_mask:0xf
    v_and_b32_dpp v38, v22, v14 row_newbcast:8 row_mask:0xf bank_mask:0xf
    v_and_b32_dpp v39, v22, v15 row_newbcast:8 row_mask:0xf bank_mask:0xf
    v_and_b32_dpp v40, v22, v12 row_newbcast:4 row_mask:0xf bank_mask:0xf
    v_and_b32_dpp v41, v22, v13 row_newbcast:4 row_mask:0xf bank_mask:0xf
    v_and_b32_dpp v42, v22, v14 row_newbcast:4 row_mask:0xf bank_mask:0xf
    v_and_b32_dpp v43, v22, v15 row_newbcast:4 row_mask:0xf bank_mask:0xf
    v_and_b32_dpp v44, v22, v12 row_newbcast:12 row_mask:0xf bank_mask:0xf
    v_and_b32_dpp v45, v22, v13 row_newbcast:12 row_mask:0xf bank_mask:0xf
    v_and_b32_dpp v46, v22, v14 row_newbcast:12 row_mask:0xf bank_mask:0xf
    v_and_b32_dpp v47, v22, v15 row_newbcast:12 row_mask:0xf bank_mask:0xf
    v_mfma_f32_16x16x32_bf16 v[16:19], v[32:35], v[208:211], v[16:19]
    v_mfma_f32_16x16x32_bf16 v[16:19], v[36:39], v[212:215], v[16:19]
    v_mfma_f32_16x16x32_bf16 v[16:19], v[40:43], v[216:219], v[16:19]
    v_mfma_f32_16x16x32_bf16 v[16:19], v[44:47], v[220:223], v[16:19]
    s_waitcnt vmcnt(2)
    buffer_load_dwordx4 v[244:247], v4, s[40:43], s69 offen offset:2048 nt
    s_waitcnt vmcnt(2)
    buffer_load_dwordx4 v[248:251], v4, s[40:43], s69 offen offset:1024 nt
    s_waitcnt vmcnt(2)
    buffer_load_dwordx4 v[252:255], v4, s[40:43], s69 offen offset:3072 nt
    s_cmp_lg_u32 s57, 0
    s_cbranch_scc1 L_mgn_skip
    v_and_b32 v145, 3, v1
    v_lshlrev_b32 v145, 7, v145
    s_lshr_b32 s80, s70, 2
    s_lshl_b32 s80, s80, 9
    s_add_u32 s80, s80, 655360
    s_mov_b64 exec, 0xff
    buffer_load_dwordx4 v[148:151], v145, s[44:47], s80 offen sc1
    s_mov_b64 exec, -1
L_mgn_skip:
    v_and_b32_dpp v32, v23, v12 row_newbcast:0 row_mask:0xf bank_mask:0xf
    v_and_b32_dpp v33, v23, v13 row_newbcast:0 row_mask:0xf bank_mask:0xf
    v_and_b32_dpp v34, v23, v14 row_newbcast:0 row_mask:0xf bank_mask:0xf
    v_and_b32_dpp v35, v23, v15 row_newbcast:0 row_mask:0xf bank_mask:0xf
    v_and_b32_dpp v36, v23, v12 row_newbcast:8 row_mask:0xf bank_mask:0xf
    v_and_b32_dpp v37, v23, v13 row_newbcast:8 row_mask:0xf bank_mask:0xf
    v_and_b32_dpp v38, v23, v14 row_newbcast:8 row_mask:0xf bank_mask:0xf
    v_and_b32_dpp v39, v23, v15 row_newbcast:8 row_mask:0xf bank_mask:0xf
    v_and_b32_dpp v40, v23, v12 row_newbcast:4 row_mask:0xf bank_mask:0xf
    v_and_b32_dpp v41, v23, v13 row_newbcast:4 row_mask:0xf bank_mask:0xf
    v_and_b32_dpp v42, v23, v14 row_newbcast:4 row_mask:0xf bank_mask:0xf
    v_and_b32_dpp v43, v23, v15 row_newbcast:4 row_mask:0xf bank_mask:0xf
    v_and_b32_dpp v44, v23, v12 row_newbcast:12 row_mask:0xf bank_mask:0xf
    v_and_b32_dpp v45, v23, v13 row_newbcast:12 row_mask:0xf bank_mask:0xf
    v_and_b32_dpp v46, v23, v14 row_newbcast:12 row_mask:0xf bank_mask:0xf
    v_and_b32_dpp v47, v23, v15 row_newbcast:12 row_mask:0xf bank_mask:0xf
    v_mfma_f32_16x16x32_bf16 v[16:19], v[32:35], v[224:227], v[16:19]
    v_mfma_f32_16x16x32_bf16 v[16:19], v[36:39], v[228:231], v[16:19]
    v_mfma_f32_16x16x32_bf16 v[16:19], v[40:43], v[232:235], v[16:19]
    v_mfma_f32_16x16x32_bf16 v[16:19], v[44:47], v[236:239], v[16:19]
    s_waitcnt vmcnt(1)
    s_xor_b32 s69, s68, 163840
    buffer_load_dwordx4 v[176:179], v4, s[40:43], s69 offen offset:0 nt
    s_waitcnt vmcnt(1)
    buffer_load_dwordx4 v[180:183], v4, s[40:43], s69 offen offset:2048 nt
    s_cmp_lg_u32 s57, 0
    s_cbranch_scc1 L_mfn_skip
    s_waitcnt vmcnt(2)
    s_mov_b32 s64, 0x20000
L_mn_chk:
    s_mov_b64 exec, 0xff
    v_xor_b32 v148, s59, v148
    v_xor_b32 v149, s60, v149
    v_xor_b32 v150, s61, v150
    v_xor_b32 v151, s62, v151
    v_or3_b32 v5, v148, v149, v150
    v_or_b32 v5, v5, v151
    v_cmp_ne_u32_sdwa vcc, v5, 0 src0_sel:BYTE_0 src1_sel:DWORD
    s_mov_b64 exec, -1
    s_cbranch_vccnz L_mn_again
L_mn_ok:
    v_max_f32_dpp v150, v148, v148 quad_perm:[1,0,3,2] row_mask:0xf bank_mask:0xf
    s_nop 1
    v_max_f32_dpp v150, v150, v150 quad_perm:[2,3,0,1] row_mask:0xf bank_mask:0xf
    v_sub_f32 v148, v148, v150
    v_sub_f32 v151, v152, v150
    v_mul_f32 v148, 0x3fb8aa3b, v148
    v_mul_f32 v151, 0x3fb8aa3b, v151
    v_exp_f32 v148, v148
    v_exp_f32 v151, v151
    v_mul_f32 v149, v149, v148
    s_nop 1
    v_add_f32_dpp v149, v149, v149 quad_perm:[1,0,3,2] row_mask:0xf bank_mask:0xf
    s_nop 1
    v_add_f32_dpp v149, v149, v149 quad_perm:[2,3,0,1] row_mask:0xf bank_mask:0xf
    v_rcp_f32 v149, v149
    s_nop 0
    v_mul_f32 v151, v151, v149
    s_nop 0
    v_readlane_b32 s65, v151, 0
    s_nop 1
    v_mov_b32 v112, s65
    v_readlane_b32 s65, v151, 1
    s_nop 1
    v_mov_b32 v113, s65
    v_readlane_b32 s65, v151, 2
    s_nop 1
    v_mov_b32 v114, s65
    v_readlane_b32 s65, v151, 3
    s_nop 1
    v_mov_b32 v115, s65
    v_readlane_b32 s65, v151, 4
    s_nop 1
    v_mov_b32 v116, s65
    v_readlane_b32 s65, v151, 5
    s_nop 1
    v_mov_b32 v117, s65
    v_readlane_b32 s65, v151, 6
    s_nop 1
    v_mov_b32 v118, s65
    v_readlane_b32 s65, v151, 7
    s_nop 1
    v_mov_b32 v119, s65
L_mfn_skip:
    v_and_b32_dpp v32, v24, v12 row_newbcast:0 row_mask:0xf bank_mask:0xf
    v_and_b32_dpp v33, v24, v13 row_newbcast:0 row_mask:0xf bank_mask:0xf
    v_and_b32_dpp v34, v24, v14 row_newbcast:0 row_mask:0xf bank_mask:0xf
    v_and_b32_dpp v35, v24, v15 row_newbcast:0 row_mask:0xf bank_mask:0xf
    v_and_b32_dpp v36, v24, v12 row_newbcast:8 row_mask:0xf bank_mask:0xf
    v_and_b32_dpp v37, v24, v13 row_newbcast:8 row_mask:0xf bank_mask:0xf
    v_and_b32_dpp v38, v24, v14 row_newbcast:8 row_mask:0xf bank_mask:0xf
    v_and_b32_dpp v39, v24, v15 row_newbcast:8 row_mask:0xf bank_mask:0xf
    v_and_b32_dpp v40, v24, v12 row_newbcast:4 row_mask:0xf bank_mask:0xf
    v_and_b32_dpp v41, v24, v13 row_newbcast:4 row_mask:0xf bank_mask:0xf
    v_and_b32_dpp v42, v24, v14 row_newbcast:4 row_mask:0xf bank_mask:0xf
    v_and_b32_dpp v43, v24, v15 row_newbcast:4 row_mask:0xf bank_mask:0xf
    v_and_b32_dpp v44, v24, v12 row_newbcast:12 row_mask:0xf bank_mask:0xf
    v_and_b32_dpp v45, v24, v13 row_newbcast:12 row_mask:0xf bank_mask:0xf
    v_and_b32_dpp v46, v24, v14 row_newbcast:12 row_mask:0xf bank_mask:0xf
    v_and_b32_dpp v47, v24, v15 row_newbcast:12 row_mask:0xf bank_mask:0xf
    v_mfma_f32_16x16x32_bf16 v[16:19], v[32:35], v[240:243], v[16:19]
    v_mfma_f32_16x16x32_bf16 v[16:19], v[36:39], v[244:247], v[16:19]
    v_mfma_f32_16x16x32_bf16 v[16:19], v[40:43], v[248:251], v[16:19]
    v_mfma_f32_16x16x32_bf16 v[16:19], v[44:47], v[252:255], v[16:19]
    s_waitcnt vmcnt(1)
    buffer_load_dwordx4 v[184:187], v4, s[40:43], s69 offen offset:1024 nt
    s_waitcnt vmcnt(1)
    buffer_load_dwordx4 v[188:191], v4, s[40:43], s69 offen offset:3072 nt
    s_waitcnt vmcnt(1)
    s_xor_b32 s69, s68, 196608
    buffer_load_dwordx4 v[192:195], v4, s[40:43], s69 offen offset:0 nt
    s_waitcnt vmcnt(1)
    buffer_load_dwordx4 v[196:199], v4, s[40:43], s69 offen offset:2048 nt
    v_and_b32_dpp v32, v25, v12 row_newbcast:0 row_mask:0xf bank_mask:0xf
    v_and_b32_dpp v33, v25, v13 row_newbcast:0 row_mask:0xf bank_mask:0xf
    v_and_b32_dpp v34, v25, v14 row_newbcast:0 row_mask:0xf bank_mask:0xf
    v_and_b32_dpp v35, v25, v15 row_newbcast:0 row_mask:0xf bank_mask:0xf
    v_and_b32_dpp v36, v25, v12 row_newbcast:8 row_mask:0xf bank_mask:0xf
    v_and_b32_dpp v37, v25, v13 row_newbcast:8 row_mask:0xf bank_mask:0xf
    v_and_b32_dpp v38, v25, v14 row_newbcast:8 row_mask:0xf bank_mask:0xf
    v_and_b32_dpp v39, v25, v15 row_newbcast:8 row_mask:0xf bank_mask:0xf
    v_and_b32_dpp v40, v25, v12 row_newbcast:4 row_mask:0xf bank_mask:0xf
    v_and_b32_dpp v41, v25, v13 row_newbcast:4 row_mask:0xf bank_mask:0xf
    v_and_b32_dpp v42, v25, v14 row_newbcast:4 row_mask:0xf bank_mask:0xf
    v_and_b32_dpp v43, v25, v15 row_newbcast:4 row_mask:0xf bank_mask:0xf
    v_and_b32_dpp v44, v25, v12 row_newbcast:12 row_mask:0xf bank_mask:0xf
    v_and_b32_dpp v45, v25, v13 row_newbcast:12 row_mask:0xf bank_mask:0xf
    v_and_b32_dpp v46, v25, v14 row_newbcast:12 row_mask:0xf bank_mask:0xf
    v_and_b32_dpp v47, v25, v15 row_newbcast:12 row_mask:0xf bank_mask:0xf
    v_mfma_f32_16x16x32_bf16 v[16:19], v[32:35], v[176:179], v[16:19]
    v_mfma_f32_16x16x32_bf16 v[16:19], v[36:39], v[180:183], v[16:19]
    v_mfma_f32_16x16x32_bf16 v[16:19], v[40:43], v[184:187], v[16:19]
    v_mfma_f32_16x16x32_bf16 v[16:19], v[44:47], v[188:191], v[16:19]
    s_waitcnt vmcnt(1)
    buffer_load_dwordx4 v[200:203], v4, s[40:43], s69 offen offset:1024 nt
    s_waitcnt vmcnt(1)
    buffer_load_dwordx4 v[204:207], v4, s[40:43], s69 offen offset:3072 nt
    s_waitcnt vmcnt(1)
    s_xor_b32 s69, s68, 229376
    buffer_load_dwordx4 v[208:211], v4, s[40:43], s69 offen offset:0 nt
    s_waitcnt vmcnt(1)
    buffer_load_dwordx4 v[212:215], v4, s[40:43], s69 offen offset:2048 nt
    v_and_b32_dpp v32, v26, v12 row_newbcast:0 row_mask:0xf bank_mask:0xf
    v_and_b32_dpp v33, v26, v13 row_newbcast:0 row_mask:0xf bank_mask:0xf
    v_and_b32_dpp v34, v26, v14 row_newbcast:0 row_mask:0xf bank_mask:0xf
    v_and_b32_dpp v35, v26, v15 row_newbcast:0 row_mask:0xf bank_mask:0xf
    v_and_b32_dpp v36, v26, v12 row_newbcast:8 row_mask:0xf bank_mask:0xf
    v_and_b32_dpp v37, v26, v13 row_newbcast:8 row_mask:0xf bank_mask:0xf
    v_and_b32_dpp v38, v26, v14 row_newbcast:8 row_mask:0xf bank_mask:0xf
    v_and_b32_dpp v39, v26, v15 row_newbcast:8 row_mask:0xf bank_mask:0xf
    v_and_b32_dpp v40, v26, v12 row_newbcast:4 row_mask:0xf bank_mask:0xf
    v_and_b32_dpp v41, v26, v13 row_newbcast:4 row_mask:0xf bank_mask:0xf
    v_and_b32_dpp v42, v26, v14 row_newbcast:4 row_mask:0xf bank_mask:0xf
    v_and_b32_dpp v43, v26, v15 row_newbcast:4 row_mask:0xf bank_mask:0xf
    v_and_b32_dpp v44, v26, v12 row_newbcast:12 row_mask:0xf bank_mask:0xf
    v_and_b32_dpp v45, v26, v13 row_newbcast:12 row_mask:0xf bank_mask:0xf
    v_and_b32_dpp v46, v26, v14 row_newbcast:12 row_mask:0xf bank_mask:0xf
    v_and_b32_dpp v47, v26, v15 row_newbcast:12 row_mask:0xf bank_mask:0xf
    v_mfma_f32_16x16x32_bf16 v[16:19], v[32:35], v[192:195], v[16:19]
    v_mfma_f32_16x16x32_bf16 v[16:19], v[36:39], v[196:199], v[16:19]
    v_mfma_f32_16x16x32_bf16 v[16:19], v[40:43], v[200:203], v[16:19]
    v_mfma_f32_16x16x32_bf16 v[16:19], v[44:47], v[204:207], v[16:19]
    s_waitcnt vmcnt(1)
    buffer_load_dwordx4 v[216:219], v4, s[40:43], s69 offen offset:1024 nt
    s_waitcnt vmcnt(1)
    buffer_load_dwordx4 v[220:223], v4, s[40:43], s69 offen offset:3072 nt
    v_and_b32_dpp v32, v27, v12 row_newbcast:0 row_mask:0xf bank_mask:0xf
    v_and_b32_dpp v33, v27, v13 row_newbcast:0 row_mask:0xf bank_mask:0xf
    v_and_b32_dpp v34, v27, v14 row_newbcast:0 row_mask:0xf bank_mask:0xf
    v_and_b32_dpp v35, v27, v15 row_newbcast:0 row_mask:0xf bank_mask:0xf
    v_and_b32_dpp v36, v27, v12 row_newbcast:8 row_mask:0xf bank_mask:0xf
    v_and_b32_dpp v37, v27, v13 row_newbcast:8 row_mask:0xf bank_mask:0xf
    v_and_b32_dpp v38, v27, v14 row_newbcast:8 row_mask:0xf bank_mask:0xf
    v_and_b32_dpp v39, v27, v15 row_newbcast:8 row_mask:0xf bank_mask:0xf
    v_and_b32_dpp v40, v27, v12 row_newbcast:4 row_mask:0xf bank_mask:0xf
    v_and_b32_dpp v41, v27, v13 row_newbcast:4 row_mask:0xf bank_mask:0xf
    v_and_b32_dpp v42, v27, v14 row_newbcast:4 row_mask:0xf bank_mask:0xf
    v_and_b32_dpp v43, v27, v15 row_newbcast:4 row_mask:0xf bank_mask:0xf
    v_and_b32_dpp v44, v27, v12 row_newbcast:12 row_mask:0xf bank_mask:0xf
    v_and_b32_dpp v45, v27, v13 row_newbcast:12 row_mask:0xf bank_mask:0xf
    v_and_b32_dpp v46, v27, v14 row_newbcast:12 row_mask:0xf bank_mask:0xf
    v_and_b32_dpp v47, v27, v15 row_newbcast:12 row_mask:0xf bank_mask:0xf
    v_mfma_f32_16x16x32_bf16 v[16:19], v[32:35], v[208:211], v[16:19]
    v_mfma_f32_16x16x32_bf16 v[16:19], v[36:39], v[212:215], v[16:19]
    s_waitcnt vmcnt(1)
    v_mfma_f32_16x16x32_bf16 v[16:19], v[40:43], v[216:219], v[16:19]
    s_waitcnt vmcnt(0)
    v_mfma_f32_16x16x32_bf16 v[16:19], v[44:47], v[220:223], v[16:19]
L_tail:
    s_mov_b32 exec_hi, 0
    s_cmp_lg_u32 s57, 0
    s_nop 5
    ds_write_b128 v146, v[16:19] offset:0
    s_mov_b32 exec_hi, -1
    s_waitcnt lgkmcnt(0)
    s_barrier
    s_cbranch_scc1 L_nos0
    ds_read_b64 v[32:33], v133 offset:0
    ds_read_b64 v[34:35], v133 offset:512
    ds_read_b64 v[36:37], v133 offset:1024
    ds_read_b64 v[38:39], v133 offset:1536
    ds_read_b64 v[40:41], v133 offset:2048
    ds_read_b64 v[42:43], v133 offset:2560
    ds_read_b64 v[44:45], v133 offset:3072
    ds_read_b64 v[46:47], v133 offset:3584
    s_cmp_eq_u32 s63, 0
    s_waitcnt lgkmcnt(6)
    v_pk_mul_f32 v[164:165], v[32:33], v[112:113] op_sel_hi:[1,0]
    v_pk_fma_f32 v[164:165], v[34:35], v[112:113], v[164:165] op_sel:[0,1,0]
    s_waitcnt lgkmcnt(2)
    v_pk_fma_f32 v[164:165], v[36:37], v[114:115], v[164:165] op_sel_hi:[1,0,1]
    v_pk_fma_f32 v[164:165], v[38:39], v[114:115], v[164:165] op_sel:[0,1,0]
    v_pk_fma_f32 v[164:165], v[40:41], v[116:117], v[164:165] op_sel_hi:[1,0,1]
    v_pk_fma_f32 v[164:165], v[42:43], v[116:117], v[164:165] op_sel:[0,1,0]
    s_waitcnt lgkmcnt(0)
    v_pk_fma_f32 v[164:165], v[44:45], v[118:119], v[164:165] op_sel_hi:[1,0,1]
    v_pk_fma_f32 v[164:165], v[46:47], v[118:119], v[164:165] op_sel:[0,1,0]
    v_bfi_b32 v164, v28, v130, v164
    v_bfi_b32 v165, v28, v131, v165
    s_cbranch_scc1 L_o_alt
    buffer_store_dwordx2 v[164:165], v128, s[44:47], 0 offen
    s_branch L_o_pub
L_o_alt:
    buffer_store_dwordx2 v[164:165], v128, s[44:47], 0 offen sc1
L_o_pub:
L_nos0:
    s_cmp_ge_u32 s79, 8
    s_cbranch_scc1 L_noy
    s_barrier
    buffer_load_dwordx4 v[32:35], v134, s[44:47], 0 offen offset:0 sc1
    buffer_load_dwordx4 v[36:39], v134, s[44:47], 0 offen offset:1024 sc1
    s_mov_b32 s64, 0x40000
    s_cmp_eq_u32 s52, 0
    s_cselect_b32 s80, s63, 0
    v_bfe_u32 v6, v1, 2, 3
    v_lshrrev_b32 v7, 1, v6
    v_lshl_add_u32 v6, v6, 2, v7
    v_and_b32 v7, 3, v1
    v_lshl_add_u32 v6, v6, 2, v7
    v_lshrrev_b32 v7, 5, v1
    v_lshl_add_u32 v6, v7, 8, v6
    s_add_u32 s65, s77, 16384
    v_lshl_add_u32 v5, v6, 3, s65
    v_xor_b32 v6, 32, v5
    v_xor_b32 v7, 64, v5
    v_xor_b32 v29, 96, v5
    v_mov_b32 v156, 0
    v_mov_b32 v157, 0
    v_mov_b32 v158, 0
    v_mov_b32 v159, 0
    v_mov_b32 v160, 0
    v_mov_b32 v161, 0
    v_mov_b32 v162, 0
    v_mov_b32 v163, 0
    v_mov_b32 v168, 0
    v_mov_b32 v169, 0
    v_mov_b32 v170, 0
    v_mov_b32 v171, 0
    v_mov_b32 v172, 0
    v_mov_b32 v173, 0
    v_mov_b32 v174, 0
    v_mov_b32 v175, 0
    s_waitcnt vmcnt(6)
    ds_read_b64_tr_b16 v[48:49], v5 offset:0
    ds_read_b64_tr_b16 v[50:51], v5 offset:1024
    ds_read_b64_tr_b16 v[56:57], v6 offset:0
    ds_read_b64_tr_b16 v[58:59], v6 offset:1024
    ds_read_b64_tr_b16 v[64:65], v7 offset:0
    ds_read_b64_tr_b16 v[66:67], v7 offset:1024
    ds_read_b64_tr_b16 v[72:73], v29 offset:0
    ds_read_b64_tr_b16 v[74:75], v29 offset:1024
    s_waitcnt vmcnt(2) lgkmcnt(0)
    ds_read_b64_tr_b16 v[52:53], v5 offset:4096
    ds_read_b64_tr_b16 v[54:55], v5 offset:5120
    ds_read_b64_tr_b16 v[60:61], v6 offset:4096
    ds_read_b64_tr_b16 v[62:63], v6 offset:5120
    ds_read_b64_tr_b16 v[68:69], v7 offset:4096
    ds_read_b64_tr_b16 v[70:71], v7 offset:5120
    ds_read_b64_tr_b16 v[76:77], v29 offset:4096
    ds_read_b64_tr_b16 v[78:79], v29 offset:5120
    s_branch L_a_chk
L_a_again:
    s_mov_b64 exec, vcc
    buffer_load_dwordx4 v[32:35], v134, s[44:47], 0 offen offset:0 sc1
    buffer_load_dwordx4 v[36:39], v134, s[44:47], 0 offen offset:1024 sc1
    s_sub_u32 s64, s64, 1
    s_cbranch_scc1 L_a_ok
L_a_chk:
    s_waitcnt vmcnt(1)
    v_xor_b32 v32, v8, v32
    v_xor_b32 v33, v9, v33
    v_xor_b32 v34, v10, v34
    v_xor_b32 v35, v11, v35
    v_or3_b32 v30, v32, v33, v34
    s_waitcnt vmcnt(0)
    v_xor_b32 v36, v8, v36
    v_xor_b32 v37, v9, v37
    v_xor_b32 v38, v10, v38
    v_xor_b32 v39, v11, v39
    v_or3_b32 v30, v30, v35, v36
    v_or3_b32 v30, v30, v37, v38
    v_or_b32 v30, v30, v39
    v_cmp_ne_u32_sdwa vcc, v30, 0 src0_sel:BYTE_0 src1_sel:DWORD
    s_cbranch_vccnz L_a_again
L_a_ok:
    s_mov_b64 exec, -1
    v_pk_add_f32 v[32:33], v[32:33], v[36:37]
    v_pk_add_f32 v[34:35], v[34:35], v[38:39]
    s_cmp_lg_u32 s57, 0
    v_add_f32_dpp v36, v32, v32 row_ror:8 row_mask:0xf bank_mask:0x3
    v_add_f32_dpp v37, v33, v33 row_ror:8 row_mask:0xf bank_mask:0x3
    v_add_f32_dpp v36, v34, v34 row_ror:8 row_mask:0xf bank_mask:0xc
    v_add_f32_dpp v37, v35, v35 row_ror:8 row_mask:0xf bank_mask:0xc
    v_cvt_pk_bf16_f32 v164, v36, v37
    s_waitcnt lgkmcnt(0)
    s_nop 0
    v_mov_b32_dpp v12, v164 quad_perm:[0,0,0,0] row_mask:0xf bank_mask:0xf
    v_mov_b32_dpp v13, v164 quad_perm:[1,1,1,1] row_mask:0xf bank_mask:0xf
    v_mov_b32_dpp v14, v164 quad_perm:[2,2,2,2] row_mask:0xf bank_mask:0xf
    v_mov_b32_dpp v15, v164 quad_perm:[3,3,3,3] row_mask:0xf bank_mask:0xf
    s_nop 1
    v_smfmac_f32_16x16x64_bf16 v[156:159], v[12:15], v[48:55], v120
    v_smfmac_f32_16x16x64_bf16 v[168:171], v[12:15], v[64:71], v120
    v_smfmac_f32_16x16x64_bf16 v[160:163], v[12:15], v[56:63], v120
    v_smfmac_f32_16x16x64_bf16 v[172:175], v[12:15], v[72:79], v120
    s_nop 6
    v_permlane32_swap_b32 v156, v168
    v_permlane32_swap_b32 v160, v172
    v_add_f32 v32, v156, v168
    v_add_f32 v33, v160, v172
    ds_write_b64 v137, v[32:33] offset:4096
    s_waitcnt lgkmcnt(0)
    s_barrier
    s_cbranch_scc1 L_noy
    ds_read_b128 v[32:35], v136 offset:4096
    ds_read_b128 v[36:39], v136 offset:4608
    ds_read_b128 v[40:43], v136 offset:5120
    ds_read_b128 v[44:47], v136 offset:5632
    s_cmp_eq_u32 s80, 0
    s_waitcnt lgkmcnt(2)
    v_pk_add_f32 v[32:33], v[32:33], v[36:37]
    v_pk_add_f32 v[34:35], v[34:35], v[38:39]
    s_waitcnt lgkmcnt(1)
    v_pk_add_f32 v[32:33], v[32:33], v[40:41]
    v_pk_add_f32 v[34:35], v[34:35], v[42:43]
    s_waitcnt lgkmcnt(0)
    v_pk_add_f32 v[32:33], v[32:33], v[44:45]
    v_pk_add_f32 v[34:35], v[34:35], v[46:47]
    s_nop 0
    v_add_f32_dpp v156, v32, v32 row_ror:8 row_mask:0xf bank_mask:0xf
    v_add_f32_dpp v157, v33, v33 row_ror:8 row_mask:0xf bank_mask:0xf
    v_add_f32_dpp v158, v34, v34 row_ror:8 row_mask:0xf bank_mask:0xf
    v_add_f32_dpp v159, v35, v35 row_ror:8 row_mask:0xf bank_mask:0xf
    v_bfi_b32 v156, v28, s59, v156
    v_bfi_b32 v157, v28, s60, v157
    v_bfi_b32 v158, v28, s61, v158
    v_bfi_b32 v159, v28, s62, v159
    s_cbranch_scc0 L_y_alt
    buffer_store_dwordx4 v[156:159], v142, s[44:47], 0 offen sc1
    s_branch L_y_pub
L_y_alt:
    buffer_store_dwordx4 v[156:159], v142, s[44:47], 0 offen
L_y_pub:
L_noy:
    s_cmp_lg_u32 s52, 0
    s_cbranch_scc1 L_fin
    v_mov_b32 v5, 14848
    ds_read_b32 v5, v5
    v_mov_b32 v8, s59
    v_mov_b32 v9, s60
    v_mov_b32 v10, s61
    v_mov_b32 v11, s62
    s_waitcnt lgkmcnt(0)
    v_readfirstlane_b32 s63, v5
    v_and_b32 v5, 0x2000, v5
    v_add_u32 v135, v5, v135
    s_and_b32 s63, s63, 1
    s_cmp_lt_u32 s53, 22
    s_barrier
    s_cbranch_scc1 L_late
    global_load_ushort v124, v122, s[8:9]
    global_load_ushort v125, v122, s[8:9] offset:32
    s_cmp_lg_u32 s57, 7
    s_cbranch_scc1 L_nob2
    v_and_b32 v6, 0x3ff, v141
    global_load_ushort v132, v6, s[26:27]
L_nob2:
    s_waitcnt vmcnt(0)
    v_lshlrev_b32 v124, 16, v124
    v_lshlrev_b32 v125, 16, v125
    s_mov_b32 s64, 0x40000
    s_mov_b64 vcc, -1
L_b_again:
    s_mov_b64 exec, vcc
    buffer_load_dwordx4 v[32:35], v135, s[44:47], 0 offen offset:0 sc1
    buffer_load_dwordx4 v[36:39], v135, s[44:47], 0 offen offset:256 sc1
    buffer_load_dwordx4 v[40:43], v135, s[44:47], 0 offen offset:512 sc1
    buffer_load_dwordx4 v[44:47], v135, s[44:47], 0 offen offset:768 sc1
    s_sub_u32 s64, s64, 1
    s_cbranch_scc1 L_b_ok
L_b_chk:
    s_waitcnt vmcnt(3)
    v_xor_b32 v32, v8, v32
    v_xor_b32 v33, v9, v33
    v_xor_b32 v34, v10, v34
    v_xor_b32 v35, v11, v35
    v_or3_b32 v30, v32, v33, v34
    s_waitcnt vmcnt(2)
    v_xor_b32 v36, v8, v36
    v_xor_b32 v37, v9, v37
    v_xor_b32 v38, v10, v38
    v_xor_b32 v39, v11, v39
    v_or3_b32 v30, v30, v35, v36
    v_or3_b32 v30, v30, v37, v38
    s_waitcnt vmcnt(1)
    v_xor_b32 v40, v8, v40
    v_xor_b32 v41, v9, v41
    v_xor_b32 v42, v10, v42
    v_xor_b32 v43, v11, v43
    v_or3_b32 v30, v30, v39, v40
    v_or3_b32 v30, v30, v41, v42
    s_waitcnt vmcnt(0)
    v_xor_b32 v44, v8, v44
    v_xor_b32 v45, v9, v45
    v_xor_b32 v46, v10, v46
    v_xor_b32 v47, v11, v47
    v_or3_b32 v30, v30, v43, v44
    v_or3_b32 v30, v30, v45, v46
    v_or_b32 v30, v30, v47
    v_cmp_ne_u32_sdwa vcc, v30, 0 src0_sel:BYTE_0 src1_sel:DWORD
    s_cbranch_vccnz L_b_again
L_b_ok:
    s_mov_b64 exec, -1
    v_pk_add_f32 v[32:33], v[32:33], v[40:41]
    v_pk_add_f32 v[34:35], v[34:35], v[42:43]
    v_pk_add_f32 v[36:37], v[36:37], v[44:45]
    v_pk_add_f32 v[38:39], v[38:39], v[46:47]
    v_pk_add_f32 v[36:37], v[32:33], v[36:37]
    v_pk_add_f32 v[38:39], v[34:35], v[38:39]
    s_cmp_ge_u32 s53, 22
    v_add_f32_dpp v32, v36, v36 row_ror:8 row_mask:0xf bank_mask:0x3
    v_add_f32_dpp v33, v37, v37 row_ror:8 row_mask:0xf bank_mask:0x3
    v_add_f32_dpp v32, v38, v38 row_ror:8 row_mask:0xf bank_mask:0xc
    v_add_f32_dpp v33, v39, v39 row_ror:8 row_mask:0xf bank_mask:0xc
    v_pk_add_f32 v[32:33], v[32:33], v[124:125]
    v_cvt_pk_bf16_f32 v164, v32, v33
    s_cbranch_scc1 L_noffn
    v_dot2_f32_bf16 v30, v164, v144, 0
    v_dot2_f32_bf16 v31, v164, v164, 0
    v_mov_b32_dpp v12, v164 quad_perm:[0,0,0,0] row_mask:0xf bank_mask:0xf
    v_mov_b32_dpp v13, v164 quad_perm:[1,1,1,1] row_mask:0xf bank_mask:0xf
    v_mov_b32_dpp v14, v164 quad_perm:[2,2,2,2] row_mask:0xf bank_mask:0xf
    v_mov_b32_dpp v15, v164 quad_perm:[3,3,3,3] row_mask:0xf bank_mask:0xf
    v_permlane32_swap_b32 v30, v31
    v_add_f32 v30, v30, v31
    v_smfmac_f32_16x16x64_bf16 v[156:159], v[12:15], v[48:55], v120
    ds_write_b32 v155, v164 offset:12288
    v_add_f32_dpp v30, v30, v30 quad_perm:[1,0,3,2] row_mask:0xf bank_mask:0xf
    v_smfmac_f32_16x16x64_bf16 v[168:171], v[12:15], v[64:71], v120
    s_cmp_ge_u32 s57, 4
    v_add_f32_dpp v30, v30, v30 quad_perm:[2,3,0,1] row_mask:0xf bank_mask:0xf
    v_smfmac_f32_16x16x64_bf16 v[160:163], v[12:15], v[56:63], v120
    v_smfmac_f32_16x16x64_bf16 v[172:175], v[12:15], v[72:79], v120
    v_add_f32_dpp v30, v30, v30 row_ror:8 row_mask:0xf bank_mask:0xf
    v_mov_b32 v31, v30
    s_nop 1
    v_permlane16_swap_b32 v30, v31
    v_add_f32 v30, v30, v31
    ds_write_b32 v138, v30 offset:14400
    v_permlane32_swap_b32 v156, v168
    v_permlane32_swap_b32 v160, v172
    v_add_f32 v32, v156, v168
    v_add_f32 v33, v160, v172
    ds_write_b64 v137, v[32:33] offset:4096
    s_waitcnt lgkmcnt(0)
    s_barrier
    s_cbranch_scc1 L_final
    ds_read_b128 v[240:243], v139 offset:14400
    ds_read_b128 v[244:247], v139 offset:14416
    ds_read_b128 v[248:251], v139 offset:14432
    ds_read_b128 v[252:255], v139 offset:14448
    ds_read_b64 v[32:33], v167 offset:4096
    ds_read_b64 v[34:35], v167 offset:4608
    ds_read_b64 v[36:37], v167 offset:5120
    ds_read_b64 v[38:39], v167 offset:5632
    ds_read_b64 v[40:41], v167 offset:6144
    ds_read_b64 v[42:43], v167 offset:6656
    ds_read_b64 v[44:45], v167 offset:7168
    ds_read_b64 v[46:47], v167 offset:7680
    s_cmp_eq_u32 s63, 0
    s_mov_b32 s65, 0x3b000000
    s_waitcnt lgkmcnt(10)
    v_pk_add_f32 v[240:241], v[240:241], v[242:243]
    v_pk_add_f32 v[244:245], v[244:245], v[246:247]
    s_waitcnt lgkmcnt(8)
    v_pk_add_f32 v[248:249], v[248:249], v[250:251]
    v_pk_add_f32 v[252:253], v[252:253], v[254:255]
    v_pk_add_f32 v[240:241], v[240:241], v[244:245]
    v_pk_add_f32 v[248:249], v[248:249], v[252:253]
    v_pk_add_f32 v[30:31], v[240:241], v[248:249]
    v_fma_f32 v31, v31, s65, v136
    v_fma_f32 v31, -v30, v30, v31
    v_max_f32 v31, v136, v31
    v_rsq_f32 v31, v31
    s_waitcnt lgkmcnt(0)
    v_pk_add_f32 v[32:33], v[32:33], v[34:35]
    v_pk_add_f32 v[36:37], v[36:37], v[38:39]
    v_pk_add_f32 v[40:41], v[40:41], v[42:43]
    v_pk_add_f32 v[44:45], v[44:45], v[46:47]
    v_pk_add_f32 v[32:33], v[32:33], v[36:37]
    v_pk_add_f32 v[40:41], v[40:41], v[44:45]
    v_pk_add_f32 v[32:33], v[32:33], v[40:41]
    v_pk_fma_f32 v[32:33], v[128:129], v[30:31], v[32:33] op_sel_hi:[1,0,1] neg_lo:[0,1,0] neg_hi:[0,1,0]
    v_pk_fma_f32 v[32:33], v[32:33], v[30:31], v[126:127] op_sel:[0,1,0]
    v_max_f32 v32, 0, v32
    v_max_f32 v33, 0, v33
    v_pk_mul_f32 v[32:33], v[32:33], v[32:33]
    v_cvt_pk_bf16_f32 v164, v32, v33
    s_nop 1
    v_and_b32_dpp v12, v164, v121 quad_perm:[0,0,0,0] row_mask:0xf bank_mask:0xf
    v_and_b32_dpp v13, v164, v121 quad_perm:[1,1,1,1] row_mask:0xf bank_mask:0xf
    v_and_b32_dpp v14, v164, v121 quad_perm:[2,2,2,2] row_mask:0xf bank_mask:0xf
    v_and_b32_dpp v15, v164, v121 quad_perm:[3,3,3,3] row_mask:0xf bank_mask:0xf
    s_nop 1
    v_smfmac_f32_16x16x64_bf16 v[208:211], v[12:15], v[80:87], v120
    v_smfmac_f32_16x16x64_bf16 v[224:227], v[12:15], v[176:183], v120
    v_smfmac_f32_16x16x64_bf16 v[212:215], v[12:15], v[88:95], v120
    v_smfmac_f32_16x16x64_bf16 v[228:231], v[12:15], v[184:191], v120
    s_nop 1
    v_smfmac_f32_16x16x64_bf16 v[216:219], v[12:15], v[96:103], v120
    s_nop 1
    v_smfmac_f32_16x16x64_bf16 v[232:235], v[12:15], v[192:199], v120
    v_permlane32_swap_b32 v208, v224
    v_add_f32 v156, v208, v224
    v_smfmac_f32_16x16x64_bf16 v[220:223], v[12:15], v[104:111], v120
    v_permlane32_swap_b32 v212, v228
    v_add_f32 v157, v212, v228
    v_smfmac_f32_16x16x64_bf16 v[236:239], v[12:15], v[200:207], v120
    v_bfi_b32 v156, v28, s59, v156
    v_bfi_b32 v157, v28, s60, v157
    v_permlane32_swap_b32 v216, v232
    v_add_f32 v158, v216, v232
    v_bfi_b32 v158, v28, s61, v158
    s_nop 2
    v_permlane32_swap_b32 v220, v236
    v_add_f32 v159, v220, v236
    v_bfi_b32 v159, v28, s62, v159
    s_cbranch_scc1 L_z_alt
    buffer_store_dwordx4 v[156:159], v142, s[44:47], 0 offen
    s_branch L_z_pub
L_z_alt:
    buffer_store_dwordx4 v[156:159], v142, s[44:47], 0 offen sc1
L_z_pub:
    s_branch L_fin
L_noffn:
    ds_write_b32 v155, v164 offset:12288
    s_lshl3_add_u32 s65, s53, s57
    s_cmp_lg_u32 s65, 248
    s_cbranch_scc1 L_noe
    s_mov_b64 exec, 1
    v_mov_b32 v6, s58
    buffer_store_dword v6, v133, s[44:47], 0 offen offset:0 sc1
    s_mov_b64 exec, -1
L_noe:
    s_waitcnt lgkmcnt(0)
    s_barrier
L_final:
    s_cmp_lg_u32 s57, 7
    s_cbranch_scc1 L_fin
    ds_read_u16 v124, v123 offset:12288
    s_mul_i32 s65, s53, 3200
    s_add_u32 s65, s65, 720896
    v_min_u32 v5, 47, v1
    v_and_b32 v5, 0x38, v5
    v_lshl_add_u32 v5, v5, 4, v154
    v_lshlrev_b32 v132, 16, v132
    s_waitcnt lgkmcnt(0)
    v_lshlrev_b32 v124, 16, v124
    v_add_f32 v124, v124, v132
    s_mov_b32 s64, 0x40000
    s_mov_b64 vcc, -1
L_c_again:
    s_mov_b64 exec, vcc
    buffer_load_dwordx4 v[32:35], v166, s[44:47], s65 offen offset:0 sc1
    buffer_load_dwordx4 v[36:39], v166, s[44:47], s65 offen offset:1024 sc1
    buffer_load_dwordx4 v[40:43], v5, s[44:47], s65 offen offset:2048 sc1
    s_sub_u32 s64, s64, 1
    s_cbranch_scc1 L_c_ok
L_c_chk:
    s_waitcnt vmcnt(2)
    v_xor_b32 v32, v8, v32
    v_xor_b32 v33, v9, v33
    v_xor_b32 v34, v10, v34
    v_xor_b32 v35, v11, v35
    v_or3_b32 v30, v32, v33, v34
    s_waitcnt vmcnt(1)
    v_xor_b32 v36, v8, v36
    v_xor_b32 v37, v9, v37
    v_xor_b32 v38, v10, v38
    v_xor_b32 v39, v11, v39
    v_or3_b32 v30, v30, v35, v36
    v_or3_b32 v30, v30, v37, v38
    s_waitcnt vmcnt(0)
    v_xor_b32 v40, v8, v40
    v_xor_b32 v41, v9, v41
    v_xor_b32 v42, v10, v42
    v_xor_b32 v43, v11, v43
    v_or3_b32 v30, v30, v39, v40
    v_or3_b32 v30, v30, v41, v42
    v_or_b32 v30, v30, v43
    v_cmp_ne_u32_sdwa vcc, v30, 0 src0_sel:BYTE_0 src1_sel:DWORD
    s_cbranch_vccnz L_c_again
L_c_ok:
    s_mov_b64 exec, -1
    v_pk_add_f32 v[32:33], v[32:33], v[36:37]
    v_pk_add_f32 v[34:35], v[34:35], v[38:39]
    s_mov_b32 exec_hi, 0xffff
    v_pk_add_f32 v[32:33], v[32:33], v[40:41]
    v_pk_add_f32 v[34:35], v[34:35], v[42:43]
    s_mov_b32 exec_hi, -1
    s_nop 0
    v_permlane32_swap_b32 v32, v34
    v_permlane32_swap_b32 v33, v35
    v_pk_add_f32 v[32:33], v[32:33], v[34:35]
    s_nop 1
    v_permlane16_swap_b32 v32, v33
    v_add_f32 v32, v32, v33
    s_nop 1
    v_add_f32_dpp v32, v32, v32 row_ror:8 row_mask:0xf bank_mask:0xf
    v_add_f32 v32, v32, v124
    v_cvt_pk_bf16_f32 v32, v32, v32
    global_store_short v141, v32, s[28:29]
L_fin:
    s_endpgm
L_late:
    s_mov_b32 s48, s24
    s_mov_b32 s49, s25
    s_mov_b32 s50, 1409024
    s_mov_b32 s51, 0x20000
    s_add_u32 m0, s77, 86016
    s_add_u32 s76, s76, 22528
    buffer_load_dwordx4 v0, s[48:51], s76 offen nt lds
    s_add_u32 m0, s77, 87040
    s_add_u32 s76, s76, 2048
    buffer_load_dwordx4 v0, s[48:51], s76 offen nt lds
    s_add_u32 m0, s77, 88064
    s_add_u32 s76, s76, 6144
    buffer_load_dwordx4 v0, s[48:51], s76 offen nt lds
    s_add_u32 m0, s77, 89088
    s_add_u32 s76, s76, 2048
    buffer_load_dwordx4 v0, s[48:51], s76 offen nt lds
    global_load_ushort v124, v122, s[8:9]
    global_load_ushort v125, v122, s[8:9] offset:32
    s_cmp_lg_u32 s57, 7
    s_cbranch_scc1 L_nob2f
    v_and_b32 v6, 0x3ff, v141
    global_load_ushort v132, v6, s[26:27]
L_nob2f:
    v_mov_b32 v156, 0
    v_mov_b32 v157, 0
    v_mov_b32 v158, 0
    v_mov_b32 v159, 0
    v_mov_b32 v160, 0
    v_mov_b32 v161, 0
    v_mov_b32 v162, 0
    v_mov_b32 v163, 0
    v_mov_b32 v168, 0
    v_mov_b32 v169, 0
    v_mov_b32 v170, 0
    v_mov_b32 v171, 0
    v_mov_b32 v172, 0
    v_mov_b32 v173, 0
    v_mov_b32 v174, 0
    v_mov_b32 v175, 0
    s_cmp_ge_u32 s57, 4
    s_cbranch_scc1 L_late2
    s_mov_b32 s72, s22
    s_mov_b32 s73, s23
    s_mov_b32 s74, 2752
    s_mov_b32 s75, 0x20000
    s_lshl_b32 s66, s53, 7
    buffer_load_ushort v126, v134, s[72:75], s66 offen
    buffer_load_ushort v127, v134, s[72:75], s66 offen offset:32
    buffer_load_dword v147, v142, s[44:47], 0 offen
    ds_read_b64 v[240:241], v167 offset:8192
    ds_read_b64 v[242:243], v167 offset:8704
    ds_read_b64 v[244:245], v167 offset:9216
    ds_read_b64 v[246:247], v167 offset:9728
    ds_read_b64 v[248:249], v167 offset:10240
    ds_read_b64 v[250:251], v167 offset:10752
    ds_read_b64 v[252:253], v167 offset:11264
    ds_read_b64 v[254:255], v167 offset:11776
    s_lshl_b32 s65, s53, 2
    s_sub_u32 s65, 86, s65
    v_cmp_gt_u32 vcc, s65, v2
    v_mov_b32 v208, 0
    v_mov_b32 v209, 0
    v_mov_b32 v210, 0
    v_mov_b32 v211, 0
    v_mov_b32 v212, 0
    v_mov_b32 v213, 0
    v_mov_b32 v214, 0
    v_mov_b32 v215, 0
    v_mov_b32 v216, 0
    v_mov_b32 v217, 0
    v_mov_b32 v218, 0
    v_mov_b32 v219, 0
    v_mov_b32 v220, 0
    v_mov_b32 v221, 0
    v_mov_b32 v222, 0
    v_mov_b32 v223, 0
    v_mov_b32 v224, 0
    v_mov_b32 v225, 0
    v_mov_b32 v226, 0
    v_mov_b32 v227, 0
    v_mov_b32 v228, 0
    v_mov_b32 v229, 0
    v_mov_b32 v230, 0
    v_mov_b32 v231, 0
    v_mov_b32 v232, 0
    v_mov_b32 v233, 0
    v_mov_b32 v234, 0
    v_mov_b32 v235, 0
    v_mov_b32 v236, 0
    v_mov_b32 v237, 0
    v_mov_b32 v238, 0
    v_mov_b32 v239, 0
    v_cndmask_b32 v121, 0, -1, vcc
    v_bfe_u32 v6, v1, 2, 3
    v_lshrrev_b32 v7, 1, v6
    v_lshl_add_u32 v6, v6, 2, v7
    v_and_b32 v7, 3, v1
    v_lshl_add_u32 v6, v6, 2, v7
    v_lshrrev_b32 v7, 5, v1
    v_lshl_add_u32 v6, v7, 8, v6
    s_add_u32 s65, s77, 81920
    v_lshl_add_u32 v5, v6, 3, s65
    v_xor_b32 v6, 32, v5
    v_xor_b32 v7, 64, v5
    v_xor_b32 v29, 96, v5
    s_waitcnt lgkmcnt(0)
    v_pk_add_f32 v[240:241], v[240:241], v[242:243]
    v_pk_add_f32 v[244:245], v[244:245], v[246:247]
    v_pk_add_f32 v[248:249], v[248:249], v[250:251]
    v_pk_add_f32 v[252:253], v[252:253], v[254:255]
    v_pk_add_f32 v[240:241], v[240:241], v[244:245]
    v_pk_add_f32 v[248:249], v[248:249], v[252:253]
    v_pk_add_f32 v[128:129], v[240:241], v[248:249]
L_late2:
    s_waitcnt vmcnt(0)
    s_barrier
    buffer_load_dwordx4 v[32:35], v135, s[44:47], 0 offen offset:0 sc1
    buffer_load_dwordx4 v[36:39], v135, s[44:47], 0 offen offset:256 sc1
    buffer_load_dwordx4 v[40:43], v135, s[44:47], 0 offen offset:512 sc1
    buffer_load_dwordx4 v[44:47], v135, s[44:47], 0 offen offset:768 sc1
    v_lshlrev_b32 v124, 16, v124
    v_lshlrev_b32 v125, 16, v125
    v_lshlrev_b32 v126, 16, v126
    v_lshlrev_b32 v127, 16, v127
    s_mov_b32 s64, 0x40000
    s_cmp_ge_u32 s57, 4
    s_cbranch_scc1 L_b_chk
    ds_read_b64_tr_b16 v[80:81], v5 offset:0
    ds_read_b64_tr_b16 v[82:83], v5 offset:1024
    ds_read_b64_tr_b16 v[88:89], v6 offset:0
    ds_read_b64_tr_b16 v[90:91], v6 offset:1024
    ds_read_b64_tr_b16 v[96:97], v7 offset:0
    ds_read_b64_tr_b16 v[98:99], v7 offset:1024
    ds_read_b64_tr_b16 v[104:105], v29 offset:0
    ds_read_b64_tr_b16 v[106:107], v29 offset:1024
    s_waitcnt lgkmcnt(4)
    ds_read_b64_tr_b16 v[84:85], v5 offset:4096
    ds_read_b64_tr_b16 v[86:87], v5 offset:5120
    ds_read_b64_tr_b16 v[92:93], v6 offset:4096
    ds_read_b64_tr_b16 v[94:95], v6 offset:5120
    ds_read_b64_tr_b16 v[100:101], v7 offset:4096
    ds_read_b64_tr_b16 v[102:103], v7 offset:5120
    ds_read_b64_tr_b16 v[108:109], v29 offset:4096
    ds_read_b64_tr_b16 v[110:111], v29 offset:5120
    s_waitcnt lgkmcnt(4)
    ds_read_b64_tr_b16 v[176:177], v5 offset:32768
    ds_read_b64_tr_b16 v[178:179], v5 offset:33792
    ds_read_b64_tr_b16 v[184:185], v6 offset:32768
    ds_read_b64_tr_b16 v[186:187], v6 offset:33792
    ds_read_b64_tr_b16 v[192:193], v7 offset:32768
    ds_read_b64_tr_b16 v[194:195], v7 offset:33792
    ds_read_b64_tr_b16 v[200:201], v29 offset:32768
    ds_read_b64_tr_b16 v[202:203], v29 offset:33792
    s_waitcnt lgkmcnt(4)
    ds_read_b64_tr_b16 v[180:181], v5 offset:36864
    ds_read_b64_tr_b16 v[182:183], v5 offset:37888
    ds_read_b64_tr_b16 v[188:189], v6 offset:36864
    ds_read_b64_tr_b16 v[190:191], v6 offset:37888
    ds_read_b64_tr_b16 v[196:197], v7 offset:36864
    ds_read_b64_tr_b16 v[198:199], v7 offset:37888
    ds_read_b64_tr_b16 v[204:205], v29 offset:36864
    ds_read_b64_tr_b16 v[206:207], v29 offset:37888
    s_branch L_b_chk
L_s_w:
    s_cmp_eq_u32 s79, 3
    s_cbranch_scc1 L_s_x
    s_waitcnt vmcnt(2)
    buffer_load_dwordx4 v[88:91], v4, s[36:39], s69 offen offset:1024 nt
    s_waitcnt vmcnt(2)
    buffer_load_dwordx4 v[92:95], v4, s[36:39], s69 offen offset:3072 nt
    s_waitcnt vmcnt(2)
    s_xor_b32 s69, s68, 98304
    buffer_load_dwordx4 v[96:99], v4, s[36:39], s69 offen offset:0 nt
    s_waitcnt vmcnt(2)
    buffer_load_dwordx4 v[100:103], v4, s[36:39], s69 offen offset:2048 nt
    s_waitcnt vmcnt(2)
    buffer_load_dwordx4 v[104:107], v4, s[36:39], s69 offen offset:1024 nt
    s_waitcnt vmcnt(2)
    buffer_load_dwordx4 v[108:111], v4, s[36:39], s69 offen offset:3072 nt
    s_cmp_lg_u32 s57, 0
    s_cbranch_scc1 L_xiw_skip
    v_and_b32 v5, 31, v1
    v_lshlrev_b32 v5, 2, v5
    s_lshl_b32 s65, s52, 7
    s_add_u32 s65, s65, 4096
    buffer_load_dword v29, v5, s[44:47], s65 offen sc1
L_xiw_skip:
    s_waitcnt vmcnt(2)
    s_xor_b32 s69, s68, 131072
    buffer_load_dwordx4 v[112:115], v4, s[36:39], s69 offen offset:0 nt
    s_waitcnt vmcnt(2)
    buffer_load_dwordx4 v[116:119], v4, s[36:39], s69 offen offset:2048 nt
    s_waitcnt vmcnt(2)
    buffer_load_dwordx4 v[120:123], v4, s[36:39], s69 offen offset:1024 nt
    s_cmp_lg_u32 s57, 0
    s_cbranch_scc1 L_xfw_skip
    s_waitcnt vmcnt(3)
    s_xor_b32 s65, s67, 134217728
    v_cmp_eq_u32 vcc, s65, v29
    v_xor_b32 v29, s67, v29
    v_and_b32 v29, 0xf7ffffff, v29
    s_bcnt1_i32_b32 s65, vcc_lo
    v_cmp_ne_u32 vcc, 0, v29
    s_cmp_ge_u32 s65, 15
    s_cselect_b32 s65, 0, 0x2000
    s_cmp_eq_u64 vcc, 0
    s_cselect_b32 s63, 1, 0
    s_or_b32 s65, s65, s63
    v_mov_b32 v5, 14848
    v_mov_b32 v6, s65
    ds_write_b32 v5, v6
    s_cmp_eq_u32 s63, 0
    s_cbranch_scc1 L_qfarw
L_xfw_skip:
    s_waitcnt vmcnt(2)
    buffer_load_dwordx4 v[124:127], v4, s[36:39], s69 offen offset:3072 nt
    s_waitcnt vmcnt(2)
    s_xor_b32 s69, s68, 163840
    buffer_load_dwordx4 v[128:131], v4, s[36:39], s69 offen offset:0 nt
    s_waitcnt vmcnt(2)
    buffer_load_dwordx4 v[132:135], v4, s[36:39], s69 offen offset:2048 nt
    s_cmp_lg_u32 s57, 1
    s_cbranch_scc1 L_qiw_skip
    s_lshl_b32 s78, s54, 13
    s_lshl_b32 s66, s56, 10
    s_add_u32 s78, s78, s66
    s_add_u32 s78, s78, 262144
    buffer_load_dwordx4 v[32:35], v7, s[44:47], s78 offen offset:0 sc1
    buffer_load_dwordx4 v[36:39], v7, s[44:47], s78 offen offset:1024 sc1
    buffer_load_dwordx4 v[40:43], v7, s[44:47], s78 offen offset:2048 sc1
    buffer_load_dwordx4 v[44:47], v7, s[44:47], s78 offen offset:3072 sc1
L_qiw_skip:
    s_waitcnt vmcnt(2)
    buffer_load_dwordx4 v[136:139], v4, s[36:39], s69 offen offset:1024 nt
    s_waitcnt vmcnt(2)
    buffer_load_dwordx4 v[140:143], v4, s[36:39], s69 offen offset:3072 nt
    s_waitcnt vmcnt(2)
    s_xor_b32 s69, s68, 196608
    buffer_load_dwordx4 v[144:147], v4, s[36:39], s69 offen offset:0 nt
    s_cmp_lg_u32 s57, 1
    s_cbranch_scc1 L_qfw_skip
    s_waitcnt vmcnt(3)
    s_mov_b32 s64, 0x20000
L_qw_chk:
    v_xor_b32 v32, s59, v32
    v_xor_b32 v33, s60, v33
    v_xor_b32 v34, s61, v34
    v_xor_b32 v35, s62, v35
    v_or3_b32 v30, v32, v33, v34
    v_xor_b32 v36, s59, v36
    v_xor_b32 v37, s60, v37
    v_xor_b32 v38, s61, v38
    v_xor_b32 v39, s62, v39
    v_or3_b32 v30, v30, v35, v36
    v_or3_b32 v30, v30, v37, v38
    v_xor_b32 v40, s59, v40
    v_xor_b32 v41, s60, v41
    v_xor_b32 v42, s61, v42
    v_xor_b32 v43, s62, v43
    v_or3_b32 v30, v30, v39, v40
    v_or3_b32 v30, v30, v41, v42
    v_xor_b32 v44, s59, v44
    v_xor_b32 v45, s60, v45
    v_xor_b32 v46, s61, v46
    v_xor_b32 v47, s62, v47
    v_or3_b32 v30, v30, v43, v44
    v_or3_b32 v30, v30, v45, v46
    v_or_b32 v30, v30, v47
    v_cmp_ne_u32_sdwa vcc, v30, 0 src0_sel:BYTE_0 src1_sel:DWORD
    s_cbranch_vccnz L_qw_again
L_qw_ok:
    v_pk_add_f32 v[32:33], v[32:33], v[40:41]
    v_pk_add_f32 v[34:35], v[34:35], v[42:43]
    v_pk_add_f32 v[36:37], v[36:37], v[44:45]
    v_pk_add_f32 v[38:39], v[38:39], v[46:47]
    v_pk_add_f32 v[32:33], v[32:33], v[36:37]
    v_pk_add_f32 v[34:35], v[34:35], v[38:39]
    v_and_b32 v5, 1, v2
    v_lshlrev_b32 v5, 3, v5
    v_permlane32_swap_b32 v32, v34
    v_permlane32_swap_b32 v33, v35
    v_lshl_add_u32 v5, v3, 4, v5
    v_lshrrev_b32 v6, 1, v2
    v_pk_add_f32 v[32:33], v[32:33], v[34:35]
    v_lshl_add_u32 v5, v6, 2, v5
    v_cvt_pk_bf16_f32 v32, v32, v33
    ds_write_b32 v5, v32 offset:14592
L_qfw_skip:
    s_waitcnt vmcnt(2)
    buffer_load_dwordx4 v[148:151], v4, s[36:39], s69 offen offset:2048 nt
    s_waitcnt vmcnt(2)
    buffer_load_dwordx4 v[152:155], v4, s[36:39], s69 offen offset:1024 nt
    s_waitcnt vmcnt(2)
    buffer_load_dwordx4 v[156:159], v4, s[36:39], s69 offen offset:3072 nt
    v_lshlrev_b32 v5, 4, v3
    s_mov_b32 s64, 0x200000
L_qrw_spin:
    ds_read_b128 v[8:11], v5 offset:14592
    s_sub_u32 s64, s64, 1
    s_cbranch_scc1 L_qrw_go
    s_waitcnt lgkmcnt(0)
    v_max3_u32 v6, v8, v9, v10
    v_max_u32 v6, v6, v11
    v_cmp_eq_u32 vcc, -1, v6
    s_cbranch_vccnz L_qrw_spin
L_qrw_go:
    s_waitcnt lgkmcnt(0)
    v_dot2_f32_bf16 v32, v48, v8, 0
    v_dot2_f32_bf16 v33, v52, v8, 0
    v_dot2_f32_bf16 v34, v56, v8, 0
    v_dot2_f32_bf16 v35, v60, v8, 0
    v_dot2_f32_bf16 v32, v49, v9, v32
    v_dot2_f32_bf16 v33, v53, v9, v33
    v_dot2_f32_bf16 v34, v57, v9, v34
    v_dot2_f32_bf16 v35, v61, v9, v35
    v_dot2_f32_bf16 v32, v50, v10, v32
    v_dot2_f32_bf16 v33, v54, v10, v33
    v_dot2_f32_bf16 v34, v58, v10, v34
    v_dot2_f32_bf16 v35, v62, v10, v35
    v_dot2_f32_bf16 v32, v51, v11, v32
    v_dot2_f32_bf16 v33, v55, v11, v33
    v_dot2_f32_bf16 v34, v59, v11, v34
    v_dot2_f32_bf16 v35, v63, v11, v35
    v_add_f32_dpp v36, v32, v32 row_ror:8 row_mask:0xf bank_mask:0x3
    v_add_f32_dpp v36, v33, v33 row_ror:8 row_mask:0xf bank_mask:0xc
    v_add_f32_dpp v37, v34, v34 row_ror:8 row_mask:0xf bank_mask:0x3
    v_add_f32_dpp v37, v35, v35 row_ror:8 row_mask:0xf bank_mask:0xc
    v_add_f32_dpp v20, v36, v36 row_shl:4 row_mask:0xf bank_mask:0x5
    s_nop 0
    v_add_f32_dpp v20, v37, v37 row_shr:4 row_mask:0xf bank_mask:0xa
    v_dot2_f32_bf16 v32, v64, v8, 0
    v_dot2_f32_bf16 v33, v68, v8, 0
    v_dot2_f32_bf16 v34, v72, v8, 0
    v_dot2_f32_bf16 v35, v76, v8, 0
    v_dot2_f32_bf16 v32, v65, v9, v32
    v_dot2_f32_bf16 v33, v69, v9, v33
    v_dot2_f32_bf16 v34, v73, v9, v34
    v_dot2_f32_bf16 v35, v77, v9, v35
    v_dot2_f32_bf16 v32, v66, v10, v32
    v_dot2_f32_bf16 v33, v70, v10, v33
    v_dot2_f32_bf16 v34, v74, v10, v34
    v_dot2_f32_bf16 v35, v78, v10, v35
    v_dot2_f32_bf16 v32, v67, v11, v32
    v_dot2_f32_bf16 v33, v71, v11, v33
    v_dot2_f32_bf16 v34, v75, v11, v34
    v_dot2_f32_bf16 v35, v79, v11, v35
    v_add_f32_dpp v36, v32, v32 row_ror:8 row_mask:0xf bank_mask:0x3
    v_add_f32_dpp v36, v33, v33 row_ror:8 row_mask:0xf bank_mask:0xc
    v_add_f32_dpp v37, v34, v34 row_ror:8 row_mask:0xf bank_mask:0x3
    v_add_f32_dpp v37, v35, v35 row_ror:8 row_mask:0xf bank_mask:0xc
    v_add_f32_dpp v21, v36, v36 row_shl:4 row_mask:0xf bank_mask:0x5
    s_nop 0
    v_add_f32_dpp v21, v37, v37 row_shr:4 row_mask:0xf bank_mask:0xa
    v_dot2_f32_bf16 v32, v80, v8, 0
    v_dot2_f32_bf16 v33, v84, v8, 0
    v_dot2_f32_bf16 v34, v88, v8, 0
    v_dot2_f32_bf16 v35, v92, v8, 0
    v_dot2_f32_bf16 v32, v81, v9, v32
    v_dot2_f32_bf16 v33, v85, v9, v33
    v_dot2_f32_bf16 v34, v89, v9, v34
    v_dot2_f32_bf16 v35, v93, v9, v35
    v_dot2_f32_bf16 v32, v82, v10, v32
    v_dot2_f32_bf16 v33, v86, v10, v33
    v_dot2_f32_bf16 v34, v90, v10, v34
    v_dot2_f32_bf16 v35, v94, v10, v35
    v_dot2_f32_bf16 v32, v83, v11, v32
    v_dot2_f32_bf16 v33, v87, v11, v33
    v_dot2_f32_bf16 v34, v91, v11, v34
    v_dot2_f32_bf16 v35, v95, v11, v35
    v_add_f32_dpp v36, v32, v32 row_ror:8 row_mask:0xf bank_mask:0x3
    v_add_f32_dpp v36, v33, v33 row_ror:8 row_mask:0xf bank_mask:0xc
    v_add_f32_dpp v37, v34, v34 row_ror:8 row_mask:0xf bank_mask:0x3
    v_add_f32_dpp v37, v35, v35 row_ror:8 row_mask:0xf bank_mask:0xc
    v_add_f32_dpp v22, v36, v36 row_shl:4 row_mask:0xf bank_mask:0x5
    s_nop 0
    v_add_f32_dpp v22, v37, v37 row_shr:4 row_mask:0xf bank_mask:0xa
    v_dot2_f32_bf16 v32, v96, v8, 0
    v_dot2_f32_bf16 v33, v100, v8, 0
    v_dot2_f32_bf16 v34, v104, v8, 0
    v_dot2_f32_bf16 v35, v108, v8, 0
    v_dot2_f32_bf16 v32, v97, v9, v32
    v_dot2_f32_bf16 v33, v101, v9, v33
    v_dot2_f32_bf16 v34, v105, v9, v34
    v_dot2_f32_bf16 v35, v109, v9, v35
    v_dot2_f32_bf16 v32, v98, v10, v32
    v_dot2_f32_bf16 v33, v102, v10, v33
    v_dot2_f32_bf16 v34, v106, v10, v34
    v_dot2_f32_bf16 v35, v110, v10, v35
    v_dot2_f32_bf16 v32, v99, v11, v32
    v_dot2_f32_bf16 v33, v103, v11, v33
    v_dot2_f32_bf16 v34, v107, v11, v34
    v_dot2_f32_bf16 v35, v111, v11, v35
    v_add_f32_dpp v36, v32, v32 row_ror:8 row_mask:0xf bank_mask:0x3
    v_add_f32_dpp v36, v33, v33 row_ror:8 row_mask:0xf bank_mask:0xc
    v_add_f32_dpp v37, v34, v34 row_ror:8 row_mask:0xf bank_mask:0x3
    v_add_f32_dpp v37, v35, v35 row_ror:8 row_mask:0xf bank_mask:0xc
    v_add_f32_dpp v23, v36, v36 row_shl:4 row_mask:0xf bank_mask:0x5
    s_nop 0
    v_add_f32_dpp v23, v37, v37 row_shr:4 row_mask:0xf bank_mask:0xa
    v_dot2_f32_bf16 v32, v112, v8, 0
    v_dot2_f32_bf16 v33, v116, v8, 0
    v_dot2_f32_bf16 v34, v120, v8, 0
    v_dot2_f32_bf16 v35, v124, v8, 0
    v_dot2_f32_bf16 v32, v113, v9, v32
    v_dot2_f32_bf16 v33, v117, v9, v33
    v_dot2_f32_bf16 v34, v121, v9, v34
    v_dot2_f32_bf16 v35, v125, v9, v35
    v_dot2_f32_bf16 v32, v114, v10, v32
    v_dot2_f32_bf16 v33, v118, v10, v33
    v_dot2_f32_bf16 v34, v122, v10, v34
    v_dot2_f32_bf16 v35, v126, v10, v35
    v_dot2_f32_bf16 v32, v115, v11, v32
    v_dot2_f32_bf16 v33, v119, v11, v33
    v_dot2_f32_bf16 v34, v123, v11, v34
    v_dot2_f32_bf16 v35, v127, v11, v35
    v_add_f32_dpp v36, v32, v32 row_ror:8 row_mask:0xf bank_mask:0x3
    v_add_f32_dpp v36, v33, v33 row_ror:8 row_mask:0xf bank_mask:0xc
    v_add_f32_dpp v37, v34, v34 row_ror:8 row_mask:0xf bank_mask:0x3
    v_add_f32_dpp v37, v35, v35 row_ror:8 row_mask:0xf bank_mask:0xc
    v_add_f32_dpp v24, v36, v36 row_shl:4 row_mask:0xf bank_mask:0x5
    s_nop 0
    v_add_f32_dpp v24, v37, v37 row_shr:4 row_mask:0xf bank_mask:0xa
    s_waitcnt vmcnt(2)
    s_xor_b32 s69, s68, 229376
    buffer_load_dwordx4 v[160:163], v4, s[36:39], s69 offen offset:0 nt
    s_waitcnt vmcnt(2)
    buffer_load_dwordx4 v[164:167], v4, s[36:39], s69 offen offset:2048 nt
    s_waitcnt vmcnt(2)
    buffer_load_dwordx4 v[168:171], v4, s[36:39], s69 offen offset:1024 nt
    v_dot2_f32_bf16 v32, v128, v8, 0
    v_dot2_f32_bf16 v33, v132, v8, 0
    v_dot2_f32_bf16 v34, v136, v8, 0
    v_dot2_f32_bf16 v35, v140, v8, 0
    v_dot2_f32_bf16 v32, v129, v9, v32
    v_dot2_f32_bf16 v33, v133, v9, v33
    v_dot2_f32_bf16 v34, v137, v9, v34
    v_dot2_f32_bf16 v35, v141, v9, v35
    v_dot2_f32_bf16 v32, v130, v10, v32
    v_dot2_f32_bf16 v33, v134, v10, v33
    v_dot2_f32_bf16 v34, v138, v10, v34
    v_dot2_f32_bf16 v35, v142, v10, v35
    v_dot2_f32_bf16 v32, v131, v11, v32
    v_dot2_f32_bf16 v33, v135, v11, v33
    v_dot2_f32_bf16 v34, v139, v11, v34
    v_dot2_f32_bf16 v35, v143, v11, v35
    v_add_f32_dpp v36, v32, v32 row_ror:8 row_mask:0xf bank_mask:0x3
    v_add_f32_dpp v36, v33, v33 row_ror:8 row_mask:0xf bank_mask:0xc
    v_add_f32_dpp v37, v34, v34 row_ror:8 row_mask:0xf bank_mask:0x3
    v_add_f32_dpp v37, v35, v35 row_ror:8 row_mask:0xf bank_mask:0xc
    v_add_f32_dpp v25, v36, v36 row_shl:4 row_mask:0xf bank_mask:0x5
    s_nop 0
    v_add_f32_dpp v25, v37, v37 row_shr:4 row_mask:0xf bank_mask:0xa
    v_dot2_f32_bf16 v32, v144, v8, 0
    v_dot2_f32_bf16 v33, v148, v8, 0
    v_dot2_f32_bf16 v34, v152, v8, 0
    v_dot2_f32_bf16 v35, v156, v8, 0
    v_dot2_f32_bf16 v32, v145, v9, v32
    v_dot2_f32_bf16 v33, v149, v9, v33
    v_dot2_f32_bf16 v34, v153, v9, v34
    v_dot2_f32_bf16 v35, v157, v9, v35
    v_dot2_f32_bf16 v32, v146, v10, v32
    v_dot2_f32_bf16 v33, v150, v10, v33
    v_dot2_f32_bf16 v34, v154, v10, v34
    v_dot2_f32_bf16 v35, v158, v10, v35
    v_dot2_f32_bf16 v32, v147, v11, v32
    v_dot2_f32_bf16 v33, v151, v11, v33
    v_dot2_f32_bf16 v34, v155, v11, v34
    v_dot2_f32_bf16 v35, v159, v11, v35
    v_add_f32_dpp v36, v32, v32 row_ror:8 row_mask:0xf bank_mask:0x3
    v_add_f32_dpp v36, v33, v33 row_ror:8 row_mask:0xf bank_mask:0xc
    v_add_f32_dpp v37, v34, v34 row_ror:8 row_mask:0xf bank_mask:0x3
    v_add_f32_dpp v37, v35, v35 row_ror:8 row_mask:0xf bank_mask:0xc
    v_add_f32_dpp v26, v36, v36 row_shl:4 row_mask:0xf bank_mask:0x5
    s_nop 0
    v_add_f32_dpp v26, v37, v37 row_shr:4 row_mask:0xf bank_mask:0xa
    s_waitcnt vmcnt(2)
    buffer_load_dwordx4 v[172:175], v4, s[36:39], s69 offen offset:3072 nt
    s_waitcnt vmcnt(2)
    buffer_load_dwordx4 v[176:179], v4, s[40:43], s68 offen offset:0 nt
    s_waitcnt vmcnt(2)
    buffer_load_dwordx4 v[180:183], v4, s[40:43], s68 offen offset:2048 nt
    s_waitcnt vmcnt(2)
    buffer_load_dwordx4 v[184:187], v4, s[40:43], s68 offen offset:1024 nt
    s_waitcnt vmcnt(2)
    buffer_load_dwordx4 v[188:191], v4, s[40:43], s68 offen offset:3072 nt
    s_waitcnt vmcnt(2)
    s_xor_b32 s69, s68, 32768
    buffer_load_dwordx4 v[192:195], v4, s[40:43], s69 offen offset:0 nt
    v_dot2_f32_bf16 v32, v160, v8, 0
    v_dot2_f32_bf16 v33, v164, v8, 0
    v_dot2_f32_bf16 v34, v168, v8, 0
    v_dot2_f32_bf16 v35, v172, v8, 0
    v_dot2_f32_bf16 v32, v161, v9, v32
    v_dot2_f32_bf16 v33, v165, v9, v33
    v_dot2_f32_bf16 v34, v169, v9, v34
    v_dot2_f32_bf16 v35, v173, v9, v35
    v_dot2_f32_bf16 v32, v162, v10, v32
    v_dot2_f32_bf16 v33, v166, v10, v33
    v_dot2_f32_bf16 v34, v170, v10, v34
    v_dot2_f32_bf16 v35, v174, v10, v35
    v_dot2_f32_bf16 v32, v163, v11, v32
    v_dot2_f32_bf16 v33, v167, v11, v33
    v_dot2_f32_bf16 v34, v171, v11, v34
    v_dot2_f32_bf16 v35, v175, v11, v35
    v_add_f32_dpp v36, v32, v32 row_ror:8 row_mask:0xf bank_mask:0x3
    v_add_f32_dpp v36, v33, v33 row_ror:8 row_mask:0xf bank_mask:0xc
    v_add_f32_dpp v37, v34, v34 row_ror:8 row_mask:0xf bank_mask:0x3
    v_add_f32_dpp v37, v35, v35 row_ror:8 row_mask:0xf bank_mask:0xc
    v_add_f32_dpp v27, v36, v36 row_shl:4 row_mask:0xf bank_mask:0x5
    s_nop 0
    v_add_f32_dpp v27, v37, v37 row_shr:4 row_mask:0xf bank_mask:0xa
    v_add_f32_dpp v20, v20, v20 quad_perm:[1,0,3,2] row_mask:0xf bank_mask:0xf
    v_add_f32_dpp v21, v21, v21 quad_perm:[1,0,3,2] row_mask:0xf bank_mask:0xf
    v_add_f32_dpp v22, v22, v22 quad_perm:[1,0,3,2] row_mask:0xf bank_mask:0xf
    v_add_f32_dpp v23, v23, v23 quad_perm:[1,0,3,2] row_mask:0xf bank_mask:0xf
    v_add_f32_dpp v24, v24, v24 quad_perm:[1,0,3,2] row_mask:0xf bank_mask:0xf
    v_add_f32_dpp v25, v25, v25 quad_perm:[1,0,3,2] row_mask:0xf bank_mask:0xf
    v_add_f32_dpp v26, v26, v26 quad_perm:[1,0,3,2] row_mask:0xf bank_mask:0xf
    v_add_f32_dpp v27, v27, v27 quad_perm:[1,0,3,2] row_mask:0xf bank_mask:0xf
    v_add_f32_dpp v20, v20, v20 quad_perm:[2,3,0,1] row_mask:0xf bank_mask:0xf
    v_add_f32_dpp v21, v21, v21 quad_perm:[2,3,0,1] row_mask:0xf bank_mask:0xf
    v_add_f32_dpp v22, v22, v22 quad_perm:[2,3,0,1] row_mask:0xf bank_mask:0xf
    v_add_f32_dpp v23, v23, v23 quad_perm:[2,3,0,1] row_mask:0xf bank_mask:0xf
    v_add_f32_dpp v24, v24, v24 quad_perm:[2,3,0,1] row_mask:0xf bank_mask:0xf
    v_add_f32_dpp v25, v25, v25 quad_perm:[2,3,0,1] row_mask:0xf bank_mask:0xf
    v_add_f32_dpp v26, v26, v26 quad_perm:[2,3,0,1] row_mask:0xf bank_mask:0xf
    v_add_f32_dpp v27, v27, v27 quad_perm:[2,3,0,1] row_mask:0xf bank_mask:0xf
    v_cvt_pk_bf16_f32 v32, v20, v21
    v_cvt_pk_bf16_f32 v33, v22, v23
    v_cvt_pk_bf16_f32 v34, v24, v25
    v_cvt_pk_bf16_f32 v35, v26, v27
    v_lshlrev_b32 v20, 16, v32
    v_and_b32 v21, 0xffff0000, v32
    v_lshlrev_b32 v22, 16, v33
    v_and_b32 v23, 0xffff0000, v33
    v_lshlrev_b32 v24, 16, v34
    v_and_b32 v25, 0xffff0000, v34
    v_lshlrev_b32 v26, 16, v35
    v_and_b32 v27, 0xffff0000, v35
    v_mul_f32 v20, 0x3db504f3, v20
    v_mul_f32 v21, 0x3db504f3, v21
    v_mul_f32 v22, 0x3db504f3, v22
    v_mul_f32 v23, 0x3db504f3, v23
    v_mul_f32 v24, 0x3db504f3, v24
    v_mul_f32 v25, 0x3db504f3, v25
    v_mul_f32 v26, 0x3db504f3, v26
    v_mul_f32 v27, 0x3db504f3, v27
    v_cvt_pk_bf16_f32 v32, v20, v21
    v_cvt_pk_bf16_f32 v33, v22, v23
    v_cvt_pk_bf16_f32 v34, v24, v25
    v_cvt_pk_bf16_f32 v35, v26, v27
    v_lshlrev_b32 v20, 16, v32
    v_and_b32 v21, 0xffff0000, v32
    v_lshlrev_b32 v22, 16, v33
    v_and_b32 v23, 0xffff0000, v33
    v_lshlrev_b32 v24, 16, v34
    v_and_b32 v25, 0xffff0000, v34
    v_lshlrev_b32 v26, 16, v35
    v_and_b32 v27, 0xffff0000, v35
    v_max3_f32 v30, v20, v21, v22
    v_max3_f32 v30, v30, v23, v24
    v_max3_f32 v30, v30, v25, v26
    v_max_f32 v30, v30, v27
    s_nop 1
    v_max_f32_dpp v30, v30, v30 row_ror:8 row_mask:0xf bank_mask:0xf
    s_nop 1
    v_max_f32_dpp v30, v30, v30 row_ror:4 row_mask:0xf bank_mask:0xf
    v_mov_b32 v32, v30
    s_nop 1
    v_permlane16_swap_b32 v30, v32
    v_max_f32 v30, v30, v32
    v_mov_b32 v32, v30
    s_nop 1
    v_permlane32_swap_b32 v30, v32
    v_max_f32 v30, v30, v32
    v_sub_f32 v20, v20, v30
    v_sub_f32 v21, v21, v30
    v_sub_f32 v22, v22, v30
    v_sub_f32 v23, v23, v30
    v_sub_f32 v24, v24, v30
    v_sub_f32 v25, v25, v30
    v_sub_f32 v26, v26, v30
    v_sub_f32 v27, v27, v30
    v_mul_f32 v20, 0x3fb8aa3b, v20
    v_mul_f32 v21, 0x3fb8aa3b, v21
    v_mul_f32 v22, 0x3fb8aa3b, v22
    v_mul_f32 v23, 0x3fb8aa3b, v23
    v_mul_f32 v24, 0x3fb8aa3b, v24
    v_mul_f32 v25, 0x3fb8aa3b, v25
    v_mul_f32 v26, 0x3fb8aa3b, v26
    v_mul_f32 v27, 0x3fb8aa3b, v27
    v_exp_f32 v20, v20
    v_exp_f32 v21, v21
    v_exp_f32 v22, v22
    v_exp_f32 v23, v23
    v_exp_f32 v24, v24
    v_exp_f32 v25, v25
    v_exp_f32 v26, v26
    v_exp_f32 v27, v27
    s_waitcnt vmcnt(2)
    buffer_load_dwordx4 v[196:199], v4, s[40:43], s69 offen offset:2048 nt
    s_waitcnt vmcnt(2)
    buffer_load_dwordx4 v[200:203], v4, s[40:43], s69 offen offset:1024 nt
    s_waitcnt vmcnt(2)
    buffer_load_dwordx4 v[204:207], v4, s[40:43], s69 offen offset:3072 nt
    s_lshl_b32 s65, s57, 3
    v_add_f32 v31, v20, v21
    v_add_f32 v31, v31, v22
    v_add_f32 v31, v31, v23
    v_add_f32 v31, v31, v24
    v_add_f32 v31, v31, v25
    v_add_f32 v31, v31, v26
    v_add_f32 v31, v31, v27
    v_cvt_pk_bf16_f32 v20, v20, v20
    v_cvt_pk_bf16_f32 v21, v21, v21
    v_cvt_pk_bf16_f32 v22, v22, v22
    v_cvt_pk_bf16_f32 v23, v23, v23
    v_cvt_pk_bf16_f32 v24, v24, v24
    v_cvt_pk_bf16_f32 v25, v25, v25
    v_cvt_pk_bf16_f32 v26, v26, v26
    v_cvt_pk_bf16_f32 v27, v27, v27
    s_nop 1
    v_add_f32_dpp v31, v31, v31 row_ror:8 row_mask:0xf bank_mask:0xf
    s_nop 1
    v_add_f32_dpp v31, v31, v31 row_ror:4 row_mask:0xf bank_mask:0xf
    v_mov_b32 v32, v31
    s_nop 1
    v_permlane16_swap_b32 v31, v32
    v_add_f32 v31, v31, v32
    v_mov_b32 v32, v31
    s_nop 1
    v_permlane32_swap_b32 v31, v32
    v_add_f32 v31, v31, v32
    v_mov_b32 v5, s65
    ds_write_b64 v5, v[30:31] offset:14336
    v_mov_b32 v8, 0x80
    v_xor_b32 v8, s59, v8
    v_mov_b32 v9, 0x80
    v_xor_b32 v9, s60, v9
    v_mov_b32 v10, 0x80
    v_xor_b32 v10, s61, v10
    v_mov_b32 v11, 0x80
    v_xor_b32 v11, s62, v11
    v_bfe_u32 v6, v1, 3, 1
    v_bfe_u32 v147, v1, 2, 1
    v_and_b32 v7, 3, v1
    v_lshlrev_b32 v133, 3, v1
    v_lshlrev_b32 v166, 4, v1
    v_and_b32 v154, 0x70, v166
    v_lshl_add_u32 v29, v7, 1, v6
    v_and_b32 v5, 1, v2
    v_lshl_add_u32 v29, v5, 3, v29
    v_lshrrev_b32 v5, 1, v2
    v_lshl_add_u32 v29, v5, 5, v29
    v_lshlrev_b32 v134, 1, v29
    v_lshl_add_u32 v122, v147, 10, v134
    s_lshl_b32 s65, s57, 7
    v_add_u32 v122, s65, v122
    v_lshl_add_u32 v29, v147, 4, v29
    v_lshlrev_b32 v167, 3, v29
    s_lshl_b32 s65, s57, 8
    v_lshl_add_u32 v155, v29, 2, s65
    s_lshr_b32 s65, s53, 3
    s_and_b32 s66, s53, 4
    s_add_u32 s65, s65, s66
    s_and_b32 s66, s53, 3
    s_lshl3_add_u32 s66, s65, s66
    s_lshl_b32 s66, s66, 5
    v_and_b32 v29, 7, v1
    v_lshl_add_u32 v123, v5, 5, v29
    v_lshl_add_u32 v123, v123, 2, s66
    v_and_b32 v5, 1, v2
    v_lshl_add_u32 v123, v5, 1, v123
    s_and_b32 s66, s53, 1
    s_lshl3_add_u32 s65, s65, s66
    s_lshl_b32 s65, s65, 4
    s_and_b32 s66, s53, 2
    s_lshl_b32 s66, s66, 9
    s_add_u32 s65, s65, s66
    v_lshl_add_u32 v141, v2, 4, v29
    v_lshl_add_u32 v141, v141, 1, s65
    v_lshlrev_b32 v135, 4, v3
    v_lshl_add_u32 v135, v2, 10, v135
    s_and_b32 s65, s57, 6
    s_add_u32 s65, s65, s57
    s_lshl_b32 s65, s65, 12
    s_add_u32 s65, s65, 65536
    v_add_u32 v135, s65, v135
    s_lshl_b32 s65, s57, 9
    v_lshlrev_b32 v146, 5, v3
    v_lshl_add_u32 v146, v2, 4, v146
    v_add_u32 v146, s65, v146
    s_lshl2_add_u32 s66, s54, 0
    s_lshl1_add_u32 s66, s66, s56
    s_lshl1_add_u32 s66, s66, s55
    s_lshl_b32 s66, s66, 9
    s_add_u32 s66, s66, 262144
    v_add_u32 v128, s66, v133
    s_xor_b32 s66, s58, 0x80808080
    v_and_b32 v29, 1, v1
    v_lshlrev_b32 v29, 4, v29
    v_lshrrev_b32 v131, v29, s66
    v_and_b32 v130, v28, v131
    v_bfe_u32 v131, v131, 8, 8
    v_add_u32 v137, s65, v133
    v_mul_u32_u24 v120, 0xaaaa, v6
    v_add_u32 v120, 0x4444, v120
    v_mad_u32_u24 v134, v147, 12, v6
    v_lshlrev_b32 v134, 9, v134
    v_lshl_add_u32 v134, v2, 6, v134
    v_lshl_add_u32 v134, v7, 4, v134
    s_and_b32 s66, s57, 1
    s_lshl_b32 s66, s66, 8
    s_lshr_b32 s65, s57, 1
    s_lshl_b32 s65, s65, 13
    s_add_u32 s66, s66, s65
    s_lshl_b32 s65, s52, 15
    s_add_u32 s66, s66, s65
    s_add_u32 s66, s66, 262144
    v_add_u32 v134, s66, v134
    v_and_b32 v136, 0x1f0, v167
    v_lshl_add_u32 v136, v6, 11, v136
    s_and_b32 s65, s79, 6
    s_add_u32 s65, s65, s79
    s_lshl_b32 s65, s65, 12
    s_add_u32 s65, s65, 65536
    s_lshl_b32 s66, s52, 7
    s_add_u32 s65, s65, s66
    v_lshl_add_u32 v142, v2, 10, v154
    v_lshl_add_u32 v142, v6, 13, v142
    v_add_u32 v142, s65, v142
    s_waitcnt vmcnt(2)
    s_xor_b32 s69, s68, 65536
    buffer_load_dwordx4 v[208:211], v4, s[40:43], s69 offen offset:0 nt
    s_waitcnt vmcnt(2)
    buffer_load_dwordx4 v[212:215], v4, s[40:43], s69 offen offset:2048 nt
    s_waitcnt vmcnt(2)
    buffer_load_dwordx4 v[216:219], v4, s[40:43], s69 offen offset:1024 nt
    s_cmp_lg_u32 s57, 0
    s_cbranch_scc1 L_mpw_skip
    v_and_b32 v5, 56, v133
    s_mov_b32 s64, 0x200000
L_mlw_spin:
    ds_read_b64 v[152:153], v5 offset:14336
    s_sub_u32 s64, s64, 1
    s_cbranch_scc1 L_mlw_go
    s_waitcnt lgkmcnt(0)
    v_cmp_eq_u32 vcc, -1, v153
    s_cbranch_vccnz L_mlw_spin
L_mlw_go:
    s_waitcnt lgkmcnt(0)
    s_nop 1
    v_max_f32_dpp v148, v152, v152 quad_perm:[1,0,3,2] row_mask:0xf bank_mask:0xf
    s_nop 1
    v_max_f32_dpp v148, v148, v148 quad_perm:[2,3,0,1] row_mask:0xf bank_mask:0xf
    s_nop 1
    v_max_f32_dpp v148, v148, v148 row_half_mirror row_mask:0xf bank_mask:0xf
    v_sub_f32 v149, v152, v148
    v_mul_f32 v149, 0x3fb8aa3b, v149
    v_exp_f32 v149, v149
    v_mov_b32 v150, 0
    v_mul_f32 v149, v149, v153
    v_mov_b32 v151, 0
    s_lshl_b32 s65, s70, 7
    v_add_f32_dpp v149, v149, v149 quad_perm:[1,0,3,2] row_mask:0xf bank_mask:0xf
    s_nop 1
    v_add_f32_dpp v149, v149, v149 quad_perm:[2,3,0,1] row_mask:0xf bank_mask:0xf
    s_nop 1
    v_add_f32_dpp v149, v149, v149 row_half_mirror row_mask:0xf bank_mask:0xf
    s_nop 1
    s_add_u32 s65, s65, 655360
    v_bfi_b32 v148, v28, s59, v148
    v_bfi_b32 v149, v28, s60, v149
    v_bfi_b32 v150, v28, s61, v150
    v_bfi_b32 v151, v28, s62, v151
    s_mov_b64 exec, 0xff
    s_cmp_eq_u32 s63, 0
    s_cbranch_scc1 L_mlw_alt
    buffer_store_dwordx4 v[148:151], v166, s[44:47], s65 offen
    s_branch L_mlw_pub
L_mlw_alt:
    buffer_store_dwordx4 v[148:151], v166, s[44:47], s65 offen sc1
L_mlw_pub:
    s_mov_b64 exec, -1
L_mpw_skip:
    v_and_b32_dpp v32, v20, v12 row_newbcast:0 row_mask:0xf bank_mask:0xf
    v_and_b32_dpp v33, v20, v13 row_newbcast:0 row_mask:0xf bank_mask:0xf
    v_and_b32_dpp v34, v20, v14 row_newbcast:0 row_mask:0xf bank_mask:0xf
    v_and_b32_dpp v35, v20, v15 row_newbcast:0 row_mask:0xf bank_mask:0xf
    v_and_b32_dpp v36, v20, v12 row_newbcast:8 row_mask:0xf bank_mask:0xf
    v_and_b32_dpp v37, v20, v13 row_newbcast:8 row_mask:0xf bank_mask:0xf
    v_and_b32_dpp v38, v20, v14 row_newbcast:8 row_mask:0xf bank_mask:0xf
    v_and_b32_dpp v39, v20, v15 row_newbcast:8 row_mask:0xf bank_mask:0xf
    v_and_b32_dpp v40, v20, v12 row_newbcast:4 row_mask:0xf bank_mask:0xf
    v_and_b32_dpp v41, v20, v13 row_newbcast:4 row_mask:0xf bank_mask:0xf
    v_and_b32_dpp v42, v20, v14 row_newbcast:4 row_mask:0xf bank_mask:0xf
    v_and_b32_dpp v43, v20, v15 row_newbcast:4 row_mask:0xf bank_mask:0xf
    v_and_b32_dpp v44, v20, v12 row_newbcast:12 row_mask:0xf bank_mask:0xf
    v_and_b32_dpp v45, v20, v13 row_newbcast:12 row_mask:0xf bank_mask:0xf
    v_and_b32_dpp v46, v20, v14 row_newbcast:12 row_mask:0xf bank_mask:0xf
    v_and_b32_dpp v47, v20, v15 row_newbcast:12 row_mask:0xf bank_mask:0xf
    v_mfma_f32_16x16x32_bf16 v[16:19], v[32:35], v[176:179], 0
    v_mfma_f32_16x16x32_bf16 v[16:19], v[36:39], v[180:183], v[16:19]
    v_mfma_f32_16x16x32_bf16 v[16:19], v[40:43], v[184:187], v[16:19]
    v_mfma_f32_16x16x32_bf16 v[16:19], v[44:47], v[188:191], v[16:19]
    v_and_b32_dpp v32, v21, v12 row_newbcast:0 row_mask:0xf bank_mask:0xf
    v_and_b32_dpp v33, v21, v13 row_newbcast:0 row_mask:0xf bank_mask:0xf
    v_and_b32_dpp v34, v21, v14 row_newbcast:0 row_mask:0xf bank_mask:0xf
    v_and_b32_dpp v35, v21, v15 row_newbcast:0 row_mask:0xf bank_mask:0xf
    v_and_b32_dpp v36, v21, v12 row_newbcast:8 row_mask:0xf bank_mask:0xf
    v_and_b32_dpp v37, v21, v13 row_newbcast:8 row_mask:0xf bank_mask:0xf
    v_and_b32_dpp v38, v21, v14 row_newbcast:8 row_mask:0xf bank_mask:0xf
    v_and_b32_dpp v39, v21, v15 row_newbcast:8 row_mask:0xf bank_mask:0xf
    v_and_b32_dpp v40, v21, v12 row_newbcast:4 row_mask:0xf bank_mask:0xf
    v_and_b32_dpp v41, v21, v13 row_newbcast:4 row_mask:0xf bank_mask:0xf
    v_and_b32_dpp v42, v21, v14 row_newbcast:4 row_mask:0xf bank_mask:0xf
    v_and_b32_dpp v43, v21, v15 row_newbcast:4 row_mask:0xf bank_mask:0xf
    v_and_b32_dpp v44, v21, v12 row_newbcast:12 row_mask:0xf bank_mask:0xf
    v_and_b32_dpp v45, v21, v13 row_newbcast:12 row_mask:0xf bank_mask:0xf
    v_and_b32_dpp v46, v21, v14 row_newbcast:12 row_mask:0xf bank_mask:0xf
    v_and_b32_dpp v47, v21, v15 row_newbcast:12 row_mask:0xf bank_mask:0xf
    v_mfma_f32_16x16x32_bf16 v[16:19], v[32:35], v[192:195], v[16:19]
    v_mfma_f32_16x16x32_bf16 v[16:19], v[36:39], v[196:199], v[16:19]
    v_mfma_f32_16x16x32_bf16 v[16:19], v[40:43], v[200:203], v[16:19]
    v_mfma_f32_16x16x32_bf16 v[16:19], v[44:47], v[204:207], v[16:19]
    s_waitcnt vmcnt(2)
    buffer_load_dwordx4 v[220:223], v4, s[40:43], s69 offen offset:3072 nt
    s_waitcnt vmcnt(2)
    s_xor_b32 s69, s68, 98304
    buffer_load_dwordx4 v[224:227], v4, s[40:43], s69 offen offset:0 nt
    s_waitcnt vmcnt(2)
    buffer_load_dwordx4 v[228:231], v4, s[40:43], s69 offen offset:2048 nt
    s_waitcnt vmcnt(2)
    buffer_load_dwordx4 v[232:235], v4, s[40:43], s69 offen offset:1024 nt
    s_waitcnt vmcnt(2)
    buffer_load_dwordx4 v[236:239], v4, s[40:43], s69 offen offset:3072 nt
    s_waitcnt vmcnt(2)
    s_xor_b32 s69, s68, 131072
    buffer_load_dwordx4 v[240:243], v4, s[40:43], s69 offen offset:0 nt
    v_and_b32_dpp v32, v22, v12 row_newbcast:0 row_mask:0xf bank_mask:0xf
    v_and_b32_dpp v33, v22, v13 row_newbcast:0 row_mask:0xf bank_mask:0xf
    v_and_b32_dpp v34, v22, v14 row_newbcast:0 row_mask:0xf bank_mask:0xf
    v_and_b32_dpp v35, v22, v15 row_newbcast:0 row_mask:0xf bank_mask:0xf
    v_and_b32_dpp v36, v22, v12 row_newbcast:8 row_mask:0xf bank_mask:0xf
    v_and_b32_dpp v37, v22, v13 row_newbcast:8 row_mask:0xf bank_mask:0xf
    v_and_b32_dpp v38, v22, v14 row_newbcast:8 row_mask:0xf bank_mask:0xf
    v_and_b32_dpp v39, v22, v15 row_newbcast:8 row_mask:0xf bank_mask:0xf
    v_and_b32_dpp v40, v22, v12 row_newbcast:4 row_mask:0xf bank_mask:0xf
    v_and_b32_dpp v41, v22, v13 row_newbcast:4 row_mask:0xf bank_mask:0xf
    v_and_b32_dpp v42, v22, v14 row_newbcast:4 row_mask:0xf bank_mask:0xf
    v_and_b32_dpp v43, v22, v15 row_newbcast:4 row_mask:0xf bank_mask:0xf
    v_and_b32_dpp v44, v22, v12 row_newbcast:12 row_mask:0xf bank_mask:0xf
    v_and_b32_dpp v45, v22, v13 row_newbcast:12 row_mask:0xf bank_mask:0xf
    v_and_b32_dpp v46, v22, v14 row_newbcast:12 row_mask:0xf bank_mask:0xf
    v_and_b32_dpp v47, v22, v15 row_newbcast:12 row_mask:0xf bank_mask:0xf
    v_mfma_f32_16x16x32_bf16 v[16:19], v[32:35], v[208:211], v[16:19]
    v_mfma_f32_16x16x32_bf16 v[16:19], v[36:39], v[212:215], v[16:19]
    v_mfma_f32_16x16x32_bf16 v[16:19], v[40:43], v[216:219], v[16:19]
    v_mfma_f32_16x16x32_bf16 v[16:19], v[44:47], v[220:223], v[16:19]
    s_waitcnt vmcnt(1)
    buffer_load_dwordx4 v[244:247], v4, s[40:43], s69 offen offset:2048 nt
    s_waitcnt vmcnt(1)
    buffer_load_dwordx4 v[248:251], v4, s[40:43], s69 offen offset:1024 nt
    v_and_b32_dpp v32, v23, v12 row_newbcast:0 row_mask:0xf bank_mask:0xf
    v_and_b32_dpp v33, v23, v13 row_newbcast:0 row_mask:0xf bank_mask:0xf
    v_and_b32_dpp v34, v23, v14 row_newbcast:0 row_mask:0xf bank_mask:0xf
    v_and_b32_dpp v35, v23, v15 row_newbcast:0 row_mask:0xf bank_mask:0xf
    v_and_b32_dpp v36, v23, v12 row_newbcast:8 row_mask:0xf bank_mask:0xf
    v_and_b32_dpp v37, v23, v13 row_newbcast:8 row_mask:0xf bank_mask:0xf
    v_and_b32_dpp v38, v23, v14 row_newbcast:8 row_mask:0xf bank_mask:0xf
    v_and_b32_dpp v39, v23, v15 row_newbcast:8 row_mask:0xf bank_mask:0xf
    v_and_b32_dpp v40, v23, v12 row_newbcast:4 row_mask:0xf bank_mask:0xf
    v_and_b32_dpp v41, v23, v13 row_newbcast:4 row_mask:0xf bank_mask:0xf
    v_and_b32_dpp v42, v23, v14 row_newbcast:4 row_mask:0xf bank_mask:0xf
    v_and_b32_dpp v43, v23, v15 row_newbcast:4 row_mask:0xf bank_mask:0xf
    v_and_b32_dpp v44, v23, v12 row_newbcast:12 row_mask:0xf bank_mask:0xf
    v_and_b32_dpp v45, v23, v13 row_newbcast:12 row_mask:0xf bank_mask:0xf
    v_and_b32_dpp v46, v23, v14 row_newbcast:12 row_mask:0xf bank_mask:0xf
    v_and_b32_dpp v47, v23, v15 row_newbcast:12 row_mask:0xf bank_mask:0xf
    v_mfma_f32_16x16x32_bf16 v[16:19], v[32:35], v[224:227], v[16:19]
    v_mfma_f32_16x16x32_bf16 v[16:19], v[36:39], v[228:231], v[16:19]
    v_mfma_f32_16x16x32_bf16 v[16:19], v[40:43], v[232:235], v[16:19]
    v_mfma_f32_16x16x32_bf16 v[16:19], v[44:47], v[236:239], v[16:19]
    s_waitcnt vmcnt(1)
    buffer_load_dwordx4 v[252:255], v4, s[40:43], s69 offen offset:3072 nt
    s_waitcnt vmcnt(1)
    s_xor_b32 s69, s68, 163840
    buffer_load_dwordx4 v[176:179], v4, s[40:43], s69 offen offset:0 nt
    s_cmp_lg_u32 s57, 0
    s_cbranch_scc1 L_mgw_skip
    v_and_b32 v145, 3, v1
    v_lshlrev_b32 v145, 7, v145
    s_lshr_b32 s80, s70, 2
    s_lshl_b32 s80, s80, 9
    s_add_u32 s80, s80, 655360
    s_mov_b64 exec, 0xff
    buffer_load_dwordx4 v[148:151], v145, s[44:47], s80 offen sc1
    s_mov_b64 exec, -1
L_mgw_skip:
    s_waitcnt vmcnt(1)
    buffer_load_dwordx4 v[180:183], v4, s[40:43], s69 offen offset:2048 nt
    s_waitcnt vmcnt(1)
    buffer_load_dwordx4 v[184:187], v4, s[40:43], s69 offen offset:1024 nt
    s_cmp_lg_u32 s57, 0
    s_cbranch_scc1 L_mfw_skip
    s_waitcnt vmcnt(2)
    s_mov_b32 s64, 0x20000
L_mw_chk:
    s_mov_b64 exec, 0xff
    v_xor_b32 v148, s59, v148
    v_xor_b32 v149, s60, v149
    v_xor_b32 v150, s61, v150
    v_xor_b32 v151, s62, v151
    v_or3_b32 v5, v148, v149, v150
    v_or_b32 v5, v5, v151
    v_cmp_ne_u32_sdwa vcc, v5, 0 src0_sel:BYTE_0 src1_sel:DWORD
    s_mov_b64 exec, -1
    s_cbranch_vccnz L_mw_again
L_mw_ok:
    v_max_f32_dpp v150, v148, v148 quad_perm:[1,0,3,2] row_mask:0xf bank_mask:0xf
    s_nop 1
    v_max_f32_dpp v150, v150, v150 quad_perm:[2,3,0,1] row_mask:0xf bank_mask:0xf
    v_sub_f32 v148, v148, v150
    v_sub_f32 v151, v152, v150
    v_mul_f32 v148, 0x3fb8aa3b, v148
    v_mul_f32 v151, 0x3fb8aa3b, v151
    v_exp_f32 v148, v148
    v_exp_f32 v151, v151
    v_mul_f32 v149, v149, v148
    s_nop 1
    v_add_f32_dpp v149, v149, v149 quad_perm:[1,0,3,2] row_mask:0xf bank_mask:0xf
    s_nop 1
    v_add_f32_dpp v149, v149, v149 quad_perm:[2,3,0,1] row_mask:0xf bank_mask:0xf
    v_rcp_f32 v149, v149
    s_nop 0
    v_mul_f32 v151, v151, v149
    s_nop 0
    v_readlane_b32 s65, v151, 0
    s_nop 1
    v_mov_b32 v112, s65
    v_readlane_b32 s65, v151, 1
    s_nop 1
    v_mov_b32 v113, s65
    v_readlane_b32 s65, v151, 2
    s_nop 1
    v_mov_b32 v114, s65
    v_readlane_b32 s65, v151, 3
    s_nop 1
    v_mov_b32 v115, s65
    v_readlane_b32 s65, v151, 4
    s_nop 1
    v_mov_b32 v116, s65
    v_readlane_b32 s65, v151, 5
    s_nop 1
    v_mov_b32 v117, s65
    v_readlane_b32 s65, v151, 6
    s_nop 1
    v_mov_b32 v118, s65
    v_readlane_b32 s65, v151, 7
    s_nop 1
    v_mov_b32 v119, s65
L_mfw_skip:
    v_and_b32_dpp v32, v24, v12 row_newbcast:0 row_mask:0xf bank_mask:0xf
    v_and_b32_dpp v33, v24, v13 row_newbcast:0 row_mask:0xf bank_mask:0xf
    v_and_b32_dpp v34, v24, v14 row_newbcast:0 row_mask:0xf bank_mask:0xf
    v_and_b32_dpp v35, v24, v15 row_newbcast:0 row_mask:0xf bank_mask:0xf
    v_and_b32_dpp v36, v24, v12 row_newbcast:8 row_mask:0xf bank_mask:0xf
    v_and_b32_dpp v37, v24, v13 row_newbcast:8 row_mask:0xf bank_mask:0xf
    v_and_b32_dpp v38, v24, v14 row_newbcast:8 row_mask:0xf bank_mask:0xf
    v_and_b32_dpp v39, v24, v15 row_newbcast:8 row_mask:0xf bank_mask:0xf
    v_and_b32_dpp v40, v24, v12 row_newbcast:4 row_mask:0xf bank_mask:0xf
    v_and_b32_dpp v41, v24, v13 row_newbcast:4 row_mask:0xf bank_mask:0xf
    v_and_b32_dpp v42, v24, v14 row_newbcast:4 row_mask:0xf bank_mask:0xf
    v_and_b32_dpp v43, v24, v15 row_newbcast:4 row_mask:0xf bank_mask:0xf
    v_and_b32_dpp v44, v24, v12 row_newbcast:12 row_mask:0xf bank_mask:0xf
    v_and_b32_dpp v45, v24, v13 row_newbcast:12 row_mask:0xf bank_mask:0xf
    v_and_b32_dpp v46, v24, v14 row_newbcast:12 row_mask:0xf bank_mask:0xf
    v_and_b32_dpp v47, v24, v15 row_newbcast:12 row_mask:0xf bank_mask:0xf
    v_mfma_f32_16x16x32_bf16 v[16:19], v[32:35], v[240:243], v[16:19]
    v_mfma_f32_16x16x32_bf16 v[16:19], v[36:39], v[244:247], v[16:19]
    v_mfma_f32_16x16x32_bf16 v[16:19], v[40:43], v[248:251], v[16:19]
    v_mfma_f32_16x16x32_bf16 v[16:19], v[44:47], v[252:255], v[16:19]
    s_waitcnt vmcnt(1)
    buffer_load_dwordx4 v[188:191], v4, s[40:43], s69 offen offset:3072 nt
    s_waitcnt vmcnt(1)
    s_xor_b32 s69, s68, 196608
    buffer_load_dwordx4 v[192:195], v4, s[40:43], s69 offen offset:0 nt
    buffer_load_dwordx4 v[196:199], v4, s[40:43], s69 offen offset:2048 nt
    s_waitcnt vmcnt(2)
    buffer_load_dwordx4 v[200:203], v4, s[40:43], s69 offen offset:1024 nt
    s_waitcnt vmcnt(2)
    buffer_load_dwordx4 v[204:207], v4, s[40:43], s69 offen offset:3072 nt
    s_waitcnt vmcnt(2)
    s_xor_b32 s69, s68, 229376
    buffer_load_dwordx4 v[208:211], v4, s[40:43], s69 offen offset:0 nt
    v_and_b32_dpp v32, v25, v12 row_newbcast:0 row_mask:0xf bank_mask:0xf
    v_and_b32_dpp v33, v25, v13 row_newbcast:0 row_mask:0xf bank_mask:0xf
    v_and_b32_dpp v34, v25, v14 row_newbcast:0 row_mask:0xf bank_mask:0xf
    v_and_b32_dpp v35, v25, v15 row_newbcast:0 row_mask:0xf bank_mask:0xf
    v_and_b32_dpp v36, v25, v12 row_newbcast:8 row_mask:0xf bank_mask:0xf
    v_and_b32_dpp v37, v25, v13 row_newbcast:8 row_mask:0xf bank_mask:0xf
    v_and_b32_dpp v38, v25, v14 row_newbcast:8 row_mask:0xf bank_mask:0xf
    v_and_b32_dpp v39, v25, v15 row_newbcast:8 row_mask:0xf bank_mask:0xf
    v_and_b32_dpp v40, v25, v12 row_newbcast:4 row_mask:0xf bank_mask:0xf
    v_and_b32_dpp v41, v25, v13 row_newbcast:4 row_mask:0xf bank_mask:0xf
    v_and_b32_dpp v42, v25, v14 row_newbcast:4 row_mask:0xf bank_mask:0xf
    v_and_b32_dpp v43, v25, v15 row_newbcast:4 row_mask:0xf bank_mask:0xf
    v_and_b32_dpp v44, v25, v12 row_newbcast:12 row_mask:0xf bank_mask:0xf
    v_and_b32_dpp v45, v25, v13 row_newbcast:12 row_mask:0xf bank_mask:0xf
    v_and_b32_dpp v46, v25, v14 row_newbcast:12 row_mask:0xf bank_mask:0xf
    v_and_b32_dpp v47, v25, v15 row_newbcast:12 row_mask:0xf bank_mask:0xf
    v_mfma_f32_16x16x32_bf16 v[16:19], v[32:35], v[176:179], v[16:19]
    v_mfma_f32_16x16x32_bf16 v[16:19], v[36:39], v[180:183], v[16:19]
    v_mfma_f32_16x16x32_bf16 v[16:19], v[40:43], v[184:187], v[16:19]
    v_mfma_f32_16x16x32_bf16 v[16:19], v[44:47], v[188:191], v[16:19]
    s_waitcnt vmcnt(2)
    buffer_load_dwordx4 v[212:215], v4, s[40:43], s69 offen offset:2048 nt
    s_waitcnt vmcnt(2)
    buffer_load_dwordx4 v[216:219], v4, s[40:43], s69 offen offset:1024 nt
    s_waitcnt vmcnt(2)
    buffer_load_dwordx4 v[220:223], v4, s[40:43], s69 offen offset:3072 nt
    v_and_b32_dpp v32, v26, v12 row_newbcast:0 row_mask:0xf bank_mask:0xf
    v_and_b32_dpp v33, v26, v13 row_newbcast:0 row_mask:0xf bank_mask:0xf
    v_and_b32_dpp v34, v26, v14 row_newbcast:0 row_mask:0xf bank_mask:0xf
    v_and_b32_dpp v35, v26, v15 row_newbcast:0 row_mask:0xf bank_mask:0xf
    v_and_b32_dpp v36, v26, v12 row_newbcast:8 row_mask:0xf bank_mask:0xf
    v_and_b32_dpp v37, v26, v13 row_newbcast:8 row_mask:0xf bank_mask:0xf
    v_and_b32_dpp v38, v26, v14 row_newbcast:8 row_mask:0xf bank_mask:0xf
    v_and_b32_dpp v39, v26, v15 row_newbcast:8 row_mask:0xf bank_mask:0xf
    v_and_b32_dpp v40, v26, v12 row_newbcast:4 row_mask:0xf bank_mask:0xf
    v_and_b32_dpp v41, v26, v13 row_newbcast:4 row_mask:0xf bank_mask:0xf
    v_and_b32_dpp v42, v26, v14 row_newbcast:4 row_mask:0xf bank_mask:0xf
    v_and_b32_dpp v43, v26, v15 row_newbcast:4 row_mask:0xf bank_mask:0xf
    v_and_b32_dpp v44, v26, v12 row_newbcast:12 row_mask:0xf bank_mask:0xf
    v_and_b32_dpp v45, v26, v13 row_newbcast:12 row_mask:0xf bank_mask:0xf
    v_and_b32_dpp v46, v26, v14 row_newbcast:12 row_mask:0xf bank_mask:0xf
    v_and_b32_dpp v47, v26, v15 row_newbcast:12 row_mask:0xf bank_mask:0xf
    v_mfma_f32_16x16x32_bf16 v[16:19], v[32:35], v[192:195], v[16:19]
    v_mfma_f32_16x16x32_bf16 v[16:19], v[36:39], v[196:199], v[16:19]
    v_mfma_f32_16x16x32_bf16 v[16:19], v[40:43], v[200:203], v[16:19]
    v_mfma_f32_16x16x32_bf16 v[16:19], v[44:47], v[204:207], v[16:19]
    v_and_b32_dpp v32, v27, v12 row_newbcast:0 row_mask:0xf bank_mask:0xf
    v_and_b32_dpp v33, v27, v13 row_newbcast:0 row_mask:0xf bank_mask:0xf
    v_and_b32_dpp v34, v27, v14 row_newbcast:0 row_mask:0xf bank_mask:0xf
    v_and_b32_dpp v35, v27, v15 row_newbcast:0 row_mask:0xf bank_mask:0xf
    v_and_b32_dpp v36, v27, v12 row_newbcast:8 row_mask:0xf bank_mask:0xf
    v_and_b32_dpp v37, v27, v13 row_newbcast:8 row_mask:0xf bank_mask:0xf
    v_and_b32_dpp v38, v27, v14 row_newbcast:8 row_mask:0xf bank_mask:0xf
    v_and_b32_dpp v39, v27, v15 row_newbcast:8 row_mask:0xf bank_mask:0xf
    v_and_b32_dpp v40, v27, v12 row_newbcast:4 row_mask:0xf bank_mask:0xf
    v_and_b32_dpp v41, v27, v13 row_newbcast:4 row_mask:0xf bank_mask:0xf
    v_and_b32_dpp v42, v27, v14 row_newbcast:4 row_mask:0xf bank_mask:0xf
    v_and_b32_dpp v43, v27, v15 row_newbcast:4 row_mask:0xf bank_mask:0xf
    v_and_b32_dpp v44, v27, v12 row_newbcast:12 row_mask:0xf bank_mask:0xf
    v_and_b32_dpp v45, v27, v13 row_newbcast:12 row_mask:0xf bank_mask:0xf
    v_and_b32_dpp v46, v27, v14 row_newbcast:12 row_mask:0xf bank_mask:0xf
    v_and_b32_dpp v47, v27, v15 row_newbcast:12 row_mask:0xf bank_mask:0xf
    v_mfma_f32_16x16x32_bf16 v[16:19], v[32:35], v[208:211], v[16:19]
    s_mov_b32 s48, s16
    s_mov_b32 s49, s17
    s_mov_b32 s50, 4194304
    s_mov_b32 s51, 0x20000
    v_lshrrev_b32 v0, 3, v1
    v_and_b32 v5, 4, v0
    v_add_u32 v0, v5, v0
    v_mul_u32_u24 v0, 1024, v0
    v_lshlrev_b32 v5, 1, v2
    v_xor_b32 v5, v1, v5
    v_and_b32 v5, 7, v5
    v_lshl_add_u32 v0, v5, 4, v0
    s_lshl_b32 s76, s52, 19
    s_lshl_b32 s66, s57, 16
    s_add_u32 s76, s76, s66
    s_lshl_b32 s66, s79, 7
    s_add_u32 m0, s77, 16384
    s_add_u32 s76, s76, s66
    buffer_load_dwordx4 v0, s[48:51], s76 offen nt lds
    s_waitcnt vmcnt(3)
    v_mfma_f32_16x16x32_bf16 v[16:19], v[36:39], v[212:215], v[16:19]
    s_add_u32 m0, s77, 17408
    s_add_u32 s76, s76, 4096
    buffer_load_dwordx4 v0, s[48:51], s76 offen nt lds
    s_waitcnt vmcnt(3)
    v_mfma_f32_16x16x32_bf16 v[16:19], v[40:43], v[216:219], v[16:19]
    s_add_u32 m0, s77, 18432
    s_add_u32 s76, s76, 12288
    buffer_load_dwordx4 v0, s[48:51], s76 offen nt lds
    s_waitcnt vmcnt(3)
    v_mfma_f32_16x16x32_bf16 v[16:19], v[44:47], v[220:223], v[16:19]
    s_add_u32 m0, s77, 19456
    s_add_u32 s76, s76, 4096
    buffer_load_dwordx4 v0, s[48:51], s76 offen nt lds
    s_add_u32 m0, s77, 20480
    s_add_u32 s76, s76, 12288
    buffer_load_dwordx4 v0, s[48:51], s76 offen nt lds
    s_add_u32 m0, s77, 21504
    s_add_u32 s76, s76, 4096
    buffer_load_dwordx4 v0, s[48:51], s76 offen nt lds
    s_add_u32 m0, s77, 22528
    s_add_u32 s76, s76, 12288
    buffer_load_dwordx4 v0, s[48:51], s76 offen nt lds
    s_add_u32 m0, s77, 23552
    s_add_u32 s76, s76, 4096
    buffer_load_dwordx4 v0, s[48:51], s76 offen nt lds
    s_branch L_tail
L_s_x:
    s_waitcnt vmcnt(2)
    buffer_load_dwordx4 v[88:91], v4, s[36:39], s69 offen offset:1024 nt
    s_waitcnt vmcnt(2)
    buffer_load_dwordx4 v[92:95], v4, s[36:39], s69 offen offset:3072 nt
    s_waitcnt vmcnt(2)
    s_xor_b32 s69, s68, 98304
    buffer_load_dwordx4 v[96:99], v4, s[36:39], s69 offen offset:0 nt
    s_waitcnt vmcnt(2)
    buffer_load_dwordx4 v[100:103], v4, s[36:39], s69 offen offset:2048 nt
    s_waitcnt vmcnt(2)
    buffer_load_dwordx4 v[104:107], v4, s[36:39], s69 offen offset:1024 nt
    s_waitcnt vmcnt(2)
    buffer_load_dwordx4 v[108:111], v4, s[36:39], s69 offen offset:3072 nt
    s_cmp_lg_u32 s57, 0
    s_cbranch_scc1 L_xix_skip
    v_and_b32 v5, 31, v1
    v_lshlrev_b32 v5, 2, v5
    s_lshl_b32 s65, s52, 7
    s_add_u32 s65, s65, 4096
    buffer_load_dword v29, v5, s[44:47], s65 offen sc1
L_xix_skip:
    s_waitcnt vmcnt(2)
    s_xor_b32 s69, s68, 131072
    buffer_load_dwordx4 v[112:115], v4, s[36:39], s69 offen offset:0 nt
    s_waitcnt vmcnt(2)
    buffer_load_dwordx4 v[116:119], v4, s[36:39], s69 offen offset:2048 nt
    s_waitcnt vmcnt(2)
    buffer_load_dwordx4 v[120:123], v4, s[36:39], s69 offen offset:1024 nt
    s_cmp_lg_u32 s57, 0
    s_cbranch_scc1 L_xfx_skip
    s_waitcnt vmcnt(3)
    s_xor_b32 s65, s67, 134217728
    v_cmp_eq_u32 vcc, s65, v29
    v_xor_b32 v29, s67, v29
    v_and_b32 v29, 0xf7ffffff, v29
    s_bcnt1_i32_b32 s65, vcc_lo
    v_cmp_ne_u32 vcc, 0, v29
    s_cmp_ge_u32 s65, 15
    s_cselect_b32 s65, 0, 0x2000
    s_cmp_eq_u64 vcc, 0
    s_cselect_b32 s63, 1, 0
    s_or_b32 s65, s65, s63
    v_mov_b32 v5, 14848
    v_mov_b32 v6, s65
    ds_write_b32 v5, v6
    s_cmp_eq_u32 s63, 0
    s_cbranch_scc1 L_qfarx
L_xfx_skip:
    s_waitcnt vmcnt(2)
    buffer_load_dwordx4 v[124:127], v4, s[36:39], s69 offen offset:3072 nt
    s_waitcnt vmcnt(2)
    s_xor_b32 s69, s68, 163840
    buffer_load_dwordx4 v[128:131], v4, s[36:39], s69 offen offset:0 nt
    s_waitcnt vmcnt(2)
    buffer_load_dwordx4 v[132:135], v4, s[36:39], s69 offen offset:2048 nt
    s_cmp_lg_u32 s57, 1
    s_cbranch_scc1 L_qix_skip
    s_lshl_b32 s78, s54, 13
    s_lshl_b32 s66, s56, 10
    s_add_u32 s78, s78, s66
    s_add_u32 s78, s78, 262144
    buffer_load_dwordx4 v[32:35], v7, s[44:47], s78 offen offset:0 sc1
    buffer_load_dwordx4 v[36:39], v7, s[44:47], s78 offen offset:1024 sc1
    buffer_load_dwordx4 v[40:43], v7, s[44:47], s78 offen offset:2048 sc1
    buffer_load_dwordx4 v[44:47], v7, s[44:47], s78 offen offset:3072 sc1
L_qix_skip:
    s_waitcnt vmcnt(2)
    buffer_load_dwordx4 v[136:139], v4, s[36:39], s69 offen offset:1024 nt
    s_waitcnt vmcnt(2)
    buffer_load_dwordx4 v[140:143], v4, s[36:39], s69 offen offset:3072 nt
    s_waitcnt vmcnt(2)
    s_xor_b32 s69, s68, 196608
    buffer_load_dwordx4 v[144:147], v4, s[36:39], s69 offen offset:0 nt
    s_cmp_lg_u32 s57, 1
    s_cbranch_scc1 L_qfx_skip
    s_waitcnt vmcnt(3)
    s_mov_b32 s64, 0x20000
L_qx_chk:
    v_xor_b32 v32, s59, v32
    v_xor_b32 v33, s60, v33
    v_xor_b32 v34, s61, v34
    v_xor_b32 v35, s62, v35
    v_or3_b32 v30, v32, v33, v34
    v_xor_b32 v36, s59, v36
    v_xor_b32 v37, s60, v37
    v_xor_b32 v38, s61, v38
    v_xor_b32 v39, s62, v39
    v_or3_b32 v30, v30, v35, v36
    v_or3_b32 v30, v30, v37, v38
    v_xor_b32 v40, s59, v40
    v_xor_b32 v41, s60, v41
    v_xor_b32 v42, s61, v42
    v_xor_b32 v43, s62, v43
    v_or3_b32 v30, v30, v39, v40
    v_or3_b32 v30, v30, v41, v42
    v_xor_b32 v44, s59, v44
    v_xor_b32 v45, s60, v45
    v_xor_b32 v46, s61, v46
    v_xor_b32 v47, s62, v47
    v_or3_b32 v30, v30, v43, v44
    v_or3_b32 v30, v30, v45, v46
    v_or_b32 v30, v30, v47
    v_cmp_ne_u32_sdwa vcc, v30, 0 src0_sel:BYTE_0 src1_sel:DWORD
    s_cbranch_vccnz L_qx_again
L_qx_ok:
    v_pk_add_f32 v[32:33], v[32:33], v[40:41]
    v_pk_add_f32 v[34:35], v[34:35], v[42:43]
    v_pk_add_f32 v[36:37], v[36:37], v[44:45]
    v_pk_add_f32 v[38:39], v[38:39], v[46:47]
    v_pk_add_f32 v[32:33], v[32:33], v[36:37]
    v_pk_add_f32 v[34:35], v[34:35], v[38:39]
    v_and_b32 v5, 1, v2
    v_lshlrev_b32 v5, 3, v5
    v_permlane32_swap_b32 v32, v34
    v_permlane32_swap_b32 v33, v35
    v_lshl_add_u32 v5, v3, 4, v5
    v_lshrrev_b32 v6, 1, v2
    v_pk_add_f32 v[32:33], v[32:33], v[34:35]
    v_lshl_add_u32 v5, v6, 2, v5
    v_cvt_pk_bf16_f32 v32, v32, v33
    ds_write_b32 v5, v32 offset:14592
L_qfx_skip:
    s_waitcnt vmcnt(2)
    buffer_load_dwordx4 v[148:151], v4, s[36:39], s69 offen offset:2048 nt
    s_waitcnt vmcnt(2)
    buffer_load_dwordx4 v[152:155], v4, s[36:39], s69 offen offset:1024 nt
    s_waitcnt vmcnt(2)
    buffer_load_dwordx4 v[156:159], v4, s[36:39], s69 offen offset:3072 nt
    v_lshlrev_b32 v5, 4, v3
    s_mov_b32 s64, 0x200000
L_qrx_spin:
    ds_read_b128 v[8:11], v5 offset:14592
    s_sub_u32 s64, s64, 1
    s_cbranch_scc1 L_qrx_go
    s_waitcnt lgkmcnt(0)
    v_max3_u32 v6, v8, v9, v10
    v_max_u32 v6, v6, v11
    v_cmp_eq_u32 vcc, -1, v6
    s_cbranch_vccnz L_qrx_spin
L_qrx_go:
    s_waitcnt lgkmcnt(0)
    v_dot2_f32_bf16 v32, v48, v8, 0
    v_dot2_f32_bf16 v33, v52, v8, 0
    v_dot2_f32_bf16 v34, v56, v8, 0
    v_dot2_f32_bf16 v35, v60, v8, 0
    v_dot2_f32_bf16 v32, v49, v9, v32
    v_dot2_f32_bf16 v33, v53, v9, v33
    v_dot2_f32_bf16 v34, v57, v9, v34
    v_dot2_f32_bf16 v35, v61, v9, v35
    v_dot2_f32_bf16 v32, v50, v10, v32
    v_dot2_f32_bf16 v33, v54, v10, v33
    v_dot2_f32_bf16 v34, v58, v10, v34
    v_dot2_f32_bf16 v35, v62, v10, v35
    v_dot2_f32_bf16 v32, v51, v11, v32
    v_dot2_f32_bf16 v33, v55, v11, v33
    v_dot2_f32_bf16 v34, v59, v11, v34
    v_dot2_f32_bf16 v35, v63, v11, v35
    v_add_f32_dpp v36, v32, v32 row_ror:8 row_mask:0xf bank_mask:0x3
    v_add_f32_dpp v36, v33, v33 row_ror:8 row_mask:0xf bank_mask:0xc
    v_add_f32_dpp v37, v34, v34 row_ror:8 row_mask:0xf bank_mask:0x3
    v_add_f32_dpp v37, v35, v35 row_ror:8 row_mask:0xf bank_mask:0xc
    v_add_f32_dpp v20, v36, v36 row_shl:4 row_mask:0xf bank_mask:0x5
    s_nop 0
    v_add_f32_dpp v20, v37, v37 row_shr:4 row_mask:0xf bank_mask:0xa
    v_dot2_f32_bf16 v32, v64, v8, 0
    v_dot2_f32_bf16 v33, v68, v8, 0
    v_dot2_f32_bf16 v34, v72, v8, 0
    v_dot2_f32_bf16 v35, v76, v8, 0
    v_dot2_f32_bf16 v32, v65, v9, v32
    v_dot2_f32_bf16 v33, v69, v9, v33
    v_dot2_f32_bf16 v34, v73, v9, v34
    v_dot2_f32_bf16 v35, v77, v9, v35
    v_dot2_f32_bf16 v32, v66, v10, v32
    v_dot2_f32_bf16 v33, v70, v10, v33
    v_dot2_f32_bf16 v34, v74, v10, v34
    v_dot2_f32_bf16 v35, v78, v10, v35
    v_dot2_f32_bf16 v32, v67, v11, v32
    v_dot2_f32_bf16 v33, v71, v11, v33
    v_dot2_f32_bf16 v34, v75, v11, v34
    v_dot2_f32_bf16 v35, v79, v11, v35
    v_add_f32_dpp v36, v32, v32 row_ror:8 row_mask:0xf bank_mask:0x3
    v_add_f32_dpp v36, v33, v33 row_ror:8 row_mask:0xf bank_mask:0xc
    v_add_f32_dpp v37, v34, v34 row_ror:8 row_mask:0xf bank_mask:0x3
    v_add_f32_dpp v37, v35, v35 row_ror:8 row_mask:0xf bank_mask:0xc
    v_add_f32_dpp v21, v36, v36 row_shl:4 row_mask:0xf bank_mask:0x5
    s_nop 0
    v_add_f32_dpp v21, v37, v37 row_shr:4 row_mask:0xf bank_mask:0xa
    v_dot2_f32_bf16 v32, v80, v8, 0
    v_dot2_f32_bf16 v33, v84, v8, 0
    v_dot2_f32_bf16 v34, v88, v8, 0
    v_dot2_f32_bf16 v35, v92, v8, 0
    v_dot2_f32_bf16 v32, v81, v9, v32
    v_dot2_f32_bf16 v33, v85, v9, v33
    v_dot2_f32_bf16 v34, v89, v9, v34
    v_dot2_f32_bf16 v35, v93, v9, v35
    v_dot2_f32_bf16 v32, v82, v10, v32
    v_dot2_f32_bf16 v33, v86, v10, v33
    v_dot2_f32_bf16 v34, v90, v10, v34
    v_dot2_f32_bf16 v35, v94, v10, v35
    v_dot2_f32_bf16 v32, v83, v11, v32
    v_dot2_f32_bf16 v33, v87, v11, v33
    v_dot2_f32_bf16 v34, v91, v11, v34
    v_dot2_f32_bf16 v35, v95, v11, v35
    v_add_f32_dpp v36, v32, v32 row_ror:8 row_mask:0xf bank_mask:0x3
    v_add_f32_dpp v36, v33, v33 row_ror:8 row_mask:0xf bank_mask:0xc
    v_add_f32_dpp v37, v34, v34 row_ror:8 row_mask:0xf bank_mask:0x3
    v_add_f32_dpp v37, v35, v35 row_ror:8 row_mask:0xf bank_mask:0xc
    v_add_f32_dpp v22, v36, v36 row_shl:4 row_mask:0xf bank_mask:0x5
    s_nop 0
    v_add_f32_dpp v22, v37, v37 row_shr:4 row_mask:0xf bank_mask:0xa
    v_dot2_f32_bf16 v32, v96, v8, 0
    v_dot2_f32_bf16 v33, v100, v8, 0
    v_dot2_f32_bf16 v34, v104, v8, 0
    v_dot2_f32_bf16 v35, v108, v8, 0
    v_dot2_f32_bf16 v32, v97, v9, v32
    v_dot2_f32_bf16 v33, v101, v9, v33
    v_dot2_f32_bf16 v34, v105, v9, v34
    v_dot2_f32_bf16 v35, v109, v9, v35
    v_dot2_f32_bf16 v32, v98, v10, v32
    v_dot2_f32_bf16 v33, v102, v10, v33
    v_dot2_f32_bf16 v34, v106, v10, v34
    v_dot2_f32_bf16 v35, v110, v10, v35
    v_dot2_f32_bf16 v32, v99, v11, v32
    v_dot2_f32_bf16 v33, v103, v11, v33
    v_dot2_f32_bf16 v34, v107, v11, v34
    v_dot2_f32_bf16 v35, v111, v11, v35
    v_add_f32_dpp v36, v32, v32 row_ror:8 row_mask:0xf bank_mask:0x3
    v_add_f32_dpp v36, v33, v33 row_ror:8 row_mask:0xf bank_mask:0xc
    v_add_f32_dpp v37, v34, v34 row_ror:8 row_mask:0xf bank_mask:0x3
    v_add_f32_dpp v37, v35, v35 row_ror:8 row_mask:0xf bank_mask:0xc
    v_add_f32_dpp v23, v36, v36 row_shl:4 row_mask:0xf bank_mask:0x5
    s_nop 0
    v_add_f32_dpp v23, v37, v37 row_shr:4 row_mask:0xf bank_mask:0xa
    v_dot2_f32_bf16 v32, v112, v8, 0
    v_dot2_f32_bf16 v33, v116, v8, 0
    v_dot2_f32_bf16 v34, v120, v8, 0
    v_dot2_f32_bf16 v35, v124, v8, 0
    v_dot2_f32_bf16 v32, v113, v9, v32
    v_dot2_f32_bf16 v33, v117, v9, v33
    v_dot2_f32_bf16 v34, v121, v9, v34
    v_dot2_f32_bf16 v35, v125, v9, v35
    v_dot2_f32_bf16 v32, v114, v10, v32
    v_dot2_f32_bf16 v33, v118, v10, v33
    v_dot2_f32_bf16 v34, v122, v10, v34
    v_dot2_f32_bf16 v35, v126, v10, v35
    v_dot2_f32_bf16 v32, v115, v11, v32
    v_dot2_f32_bf16 v33, v119, v11, v33
    v_dot2_f32_bf16 v34, v123, v11, v34
    v_dot2_f32_bf16 v35, v127, v11, v35
    v_add_f32_dpp v36, v32, v32 row_ror:8 row_mask:0xf bank_mask:0x3
    v_add_f32_dpp v36, v33, v33 row_ror:8 row_mask:0xf bank_mask:0xc
    v_add_f32_dpp v37, v34, v34 row_ror:8 row_mask:0xf bank_mask:0x3
    v_add_f32_dpp v37, v35, v35 row_ror:8 row_mask:0xf bank_mask:0xc
    v_add_f32_dpp v24, v36, v36 row_shl:4 row_mask:0xf bank_mask:0x5
    s_nop 0
    v_add_f32_dpp v24, v37, v37 row_shr:4 row_mask:0xf bank_mask:0xa
    s_waitcnt vmcnt(2)
    s_xor_b32 s69, s68, 229376
    buffer_load_dwordx4 v[160:163], v4, s[36:39], s69 offen offset:0 nt
    s_waitcnt vmcnt(2)
    buffer_load_dwordx4 v[164:167], v4, s[36:39], s69 offen offset:2048 nt
    s_waitcnt vmcnt(2)
    buffer_load_dwordx4 v[168:171], v4, s[36:39], s69 offen offset:1024 nt
    v_dot2_f32_bf16 v32, v128, v8, 0
    v_dot2_f32_bf16 v33, v132, v8, 0
    v_dot2_f32_bf16 v34, v136, v8, 0
    v_dot2_f32_bf16 v35, v140, v8, 0
    v_dot2_f32_bf16 v32, v129, v9, v32
    v_dot2_f32_bf16 v33, v133, v9, v33
    v_dot2_f32_bf16 v34, v137, v9, v34
    v_dot2_f32_bf16 v35, v141, v9, v35
    v_dot2_f32_bf16 v32, v130, v10, v32
    v_dot2_f32_bf16 v33, v134, v10, v33
    v_dot2_f32_bf16 v34, v138, v10, v34
    v_dot2_f32_bf16 v35, v142, v10, v35
    v_dot2_f32_bf16 v32, v131, v11, v32
    v_dot2_f32_bf16 v33, v135, v11, v33
    v_dot2_f32_bf16 v34, v139, v11, v34
    v_dot2_f32_bf16 v35, v143, v11, v35
    v_add_f32_dpp v36, v32, v32 row_ror:8 row_mask:0xf bank_mask:0x3
    v_add_f32_dpp v36, v33, v33 row_ror:8 row_mask:0xf bank_mask:0xc
    v_add_f32_dpp v37, v34, v34 row_ror:8 row_mask:0xf bank_mask:0x3
    v_add_f32_dpp v37, v35, v35 row_ror:8 row_mask:0xf bank_mask:0xc
    v_add_f32_dpp v25, v36, v36 row_shl:4 row_mask:0xf bank_mask:0x5
    s_nop 0
    v_add_f32_dpp v25, v37, v37 row_shr:4 row_mask:0xf bank_mask:0xa
    v_dot2_f32_bf16 v32, v144, v8, 0
    v_dot2_f32_bf16 v33, v148, v8, 0
    v_dot2_f32_bf16 v34, v152, v8, 0
    v_dot2_f32_bf16 v35, v156, v8, 0
    v_dot2_f32_bf16 v32, v145, v9, v32
    v_dot2_f32_bf16 v33, v149, v9, v33
    v_dot2_f32_bf16 v34, v153, v9, v34
    v_dot2_f32_bf16 v35, v157, v9, v35
    v_dot2_f32_bf16 v32, v146, v10, v32
    v_dot2_f32_bf16 v33, v150, v10, v33
    v_dot2_f32_bf16 v34, v154, v10, v34
    v_dot2_f32_bf16 v35, v158, v10, v35
    v_dot2_f32_bf16 v32, v147, v11, v32
    v_dot2_f32_bf16 v33, v151, v11, v33
    v_dot2_f32_bf16 v34, v155, v11, v34
    v_dot2_f32_bf16 v35, v159, v11, v35
    v_add_f32_dpp v36, v32, v32 row_ror:8 row_mask:0xf bank_mask:0x3
    v_add_f32_dpp v36, v33, v33 row_ror:8 row_mask:0xf bank_mask:0xc
    v_add_f32_dpp v37, v34, v34 row_ror:8 row_mask:0xf bank_mask:0x3
    v_add_f32_dpp v37, v35, v35 row_ror:8 row_mask:0xf bank_mask:0xc
    v_add_f32_dpp v26, v36, v36 row_shl:4 row_mask:0xf bank_mask:0x5
    s_nop 0
    v_add_f32_dpp v26, v37, v37 row_shr:4 row_mask:0xf bank_mask:0xa
    s_waitcnt vmcnt(2)
    buffer_load_dwordx4 v[172:175], v4, s[36:39], s69 offen offset:3072 nt
    s_waitcnt vmcnt(2)
    buffer_load_dwordx4 v[176:179], v4, s[40:43], s68 offen offset:0 nt
    s_waitcnt vmcnt(2)
    buffer_load_dwordx4 v[180:183], v4, s[40:43], s68 offen offset:2048 nt
    s_waitcnt vmcnt(2)
    buffer_load_dwordx4 v[184:187], v4, s[40:43], s68 offen offset:1024 nt
    s_waitcnt vmcnt(2)
    buffer_load_dwordx4 v[188:191], v4, s[40:43], s68 offen offset:3072 nt
    s_waitcnt vmcnt(2)
    s_xor_b32 s69, s68, 32768
    buffer_load_dwordx4 v[192:195], v4, s[40:43], s69 offen offset:0 nt
    v_dot2_f32_bf16 v32, v160, v8, 0
    v_dot2_f32_bf16 v33, v164, v8, 0
    v_dot2_f32_bf16 v34, v168, v8, 0
    v_dot2_f32_bf16 v35, v172, v8, 0
    v_dot2_f32_bf16 v32, v161, v9, v32
    v_dot2_f32_bf16 v33, v165, v9, v33
    v_dot2_f32_bf16 v34, v169, v9, v34
    v_dot2_f32_bf16 v35, v173, v9, v35
    v_dot2_f32_bf16 v32, v162, v10, v32
    v_dot2_f32_bf16 v33, v166, v10, v33
    v_dot2_f32_bf16 v34, v170, v10, v34
    v_dot2_f32_bf16 v35, v174, v10, v35
    v_dot2_f32_bf16 v32, v163, v11, v32
    v_dot2_f32_bf16 v33, v167, v11, v33
    v_dot2_f32_bf16 v34, v171, v11, v34
    v_dot2_f32_bf16 v35, v175, v11, v35
    v_add_f32_dpp v36, v32, v32 row_ror:8 row_mask:0xf bank_mask:0x3
    v_add_f32_dpp v36, v33, v33 row_ror:8 row_mask:0xf bank_mask:0xc
    v_add_f32_dpp v37, v34, v34 row_ror:8 row_mask:0xf bank_mask:0x3
    v_add_f32_dpp v37, v35, v35 row_ror:8 row_mask:0xf bank_mask:0xc
    v_add_f32_dpp v27, v36, v36 row_shl:4 row_mask:0xf bank_mask:0x5
    s_nop 0
    v_add_f32_dpp v27, v37, v37 row_shr:4 row_mask:0xf bank_mask:0xa
    v_add_f32_dpp v20, v20, v20 quad_perm:[1,0,3,2] row_mask:0xf bank_mask:0xf
    v_add_f32_dpp v21, v21, v21 quad_perm:[1,0,3,2] row_mask:0xf bank_mask:0xf
    v_add_f32_dpp v22, v22, v22 quad_perm:[1,0,3,2] row_mask:0xf bank_mask:0xf
    v_add_f32_dpp v23, v23, v23 quad_perm:[1,0,3,2] row_mask:0xf bank_mask:0xf
    v_add_f32_dpp v24, v24, v24 quad_perm:[1,0,3,2] row_mask:0xf bank_mask:0xf
    v_add_f32_dpp v25, v25, v25 quad_perm:[1,0,3,2] row_mask:0xf bank_mask:0xf
    v_add_f32_dpp v26, v26, v26 quad_perm:[1,0,3,2] row_mask:0xf bank_mask:0xf
    v_add_f32_dpp v27, v27, v27 quad_perm:[1,0,3,2] row_mask:0xf bank_mask:0xf
    v_add_f32_dpp v20, v20, v20 quad_perm:[2,3,0,1] row_mask:0xf bank_mask:0xf
    v_add_f32_dpp v21, v21, v21 quad_perm:[2,3,0,1] row_mask:0xf bank_mask:0xf
    v_add_f32_dpp v22, v22, v22 quad_perm:[2,3,0,1] row_mask:0xf bank_mask:0xf
    v_add_f32_dpp v23, v23, v23 quad_perm:[2,3,0,1] row_mask:0xf bank_mask:0xf
    v_add_f32_dpp v24, v24, v24 quad_perm:[2,3,0,1] row_mask:0xf bank_mask:0xf
    v_add_f32_dpp v25, v25, v25 quad_perm:[2,3,0,1] row_mask:0xf bank_mask:0xf
    v_add_f32_dpp v26, v26, v26 quad_perm:[2,3,0,1] row_mask:0xf bank_mask:0xf
    v_add_f32_dpp v27, v27, v27 quad_perm:[2,3,0,1] row_mask:0xf bank_mask:0xf
    v_cvt_pk_bf16_f32 v32, v20, v21
    v_cvt_pk_bf16_f32 v33, v22, v23
    v_cvt_pk_bf16_f32 v34, v24, v25
    v_cvt_pk_bf16_f32 v35, v26, v27
    v_lshlrev_b32 v20, 16, v32
    v_and_b32 v21, 0xffff0000, v32
    v_lshlrev_b32 v22, 16, v33
    v_and_b32 v23, 0xffff0000, v33
    v_lshlrev_b32 v24, 16, v34
    v_and_b32 v25, 0xffff0000, v34
    v_lshlrev_b32 v26, 16, v35
    v_and_b32 v27, 0xffff0000, v35
    v_mul_f32 v20, 0x3db504f3, v20
    v_mul_f32 v21, 0x3db504f3, v21
    v_mul_f32 v22, 0x3db504f3, v22
    v_mul_f32 v23, 0x3db504f3, v23
    v_mul_f32 v24, 0x3db504f3, v24
    v_mul_f32 v25, 0x3db504f3, v25
    v_mul_f32 v26, 0x3db504f3, v26
    v_mul_f32 v27, 0x3db504f3, v27
    v_cvt_pk_bf16_f32 v32, v20, v21
    v_cvt_pk_bf16_f32 v33, v22, v23
    v_cvt_pk_bf16_f32 v34, v24, v25
    v_cvt_pk_bf16_f32 v35, v26, v27
    v_lshlrev_b32 v20, 16, v32
    v_and_b32 v21, 0xffff0000, v32
    v_lshlrev_b32 v22, 16, v33
    v_and_b32 v23, 0xffff0000, v33
    v_lshlrev_b32 v24, 16, v34
    v_and_b32 v25, 0xffff0000, v34
    v_lshlrev_b32 v26, 16, v35
    v_and_b32 v27, 0xffff0000, v35
    v_max3_f32 v30, v20, v21, v22
    v_max3_f32 v30, v30, v23, v24
    v_max3_f32 v30, v30, v25, v26
    v_max_f32 v30, v30, v27
    s_nop 1
    v_max_f32_dpp v30, v30, v30 row_ror:8 row_mask:0xf bank_mask:0xf
    s_nop 1
    v_max_f32_dpp v30, v30, v30 row_ror:4 row_mask:0xf bank_mask:0xf
    v_mov_b32 v32, v30
    s_nop 1
    v_permlane16_swap_b32 v30, v32
    v_max_f32 v30, v30, v32
    v_mov_b32 v32, v30
    s_nop 1
    v_permlane32_swap_b32 v30, v32
    v_max_f32 v30, v30, v32
    v_sub_f32 v20, v20, v30
    v_sub_f32 v21, v21, v30
    v_sub_f32 v22, v22, v30
    v_sub_f32 v23, v23, v30
    v_sub_f32 v24, v24, v30
    v_sub_f32 v25, v25, v30
    v_sub_f32 v26, v26, v30
    v_sub_f32 v27, v27, v30
    v_mul_f32 v20, 0x3fb8aa3b, v20
    v_mul_f32 v21, 0x3fb8aa3b, v21
    v_mul_f32 v22, 0x3fb8aa3b, v22
    v_mul_f32 v23, 0x3fb8aa3b, v23
    v_mul_f32 v24, 0x3fb8aa3b, v24
    v_mul_f32 v25, 0x3fb8aa3b, v25
    v_mul_f32 v26, 0x3fb8aa3b, v26
    v_mul_f32 v27, 0x3fb8aa3b, v27
    v_exp_f32 v20, v20
    v_exp_f32 v21, v21
    v_exp_f32 v22, v22
    v_exp_f32 v23, v23
    v_exp_f32 v24, v24
    v_exp_f32 v25, v25
    v_exp_f32 v26, v26
    v_exp_f32 v27, v27
    s_waitcnt vmcnt(2)
    buffer_load_dwordx4 v[196:199], v4, s[40:43], s69 offen offset:2048 nt
    s_waitcnt vmcnt(2)
    buffer_load_dwordx4 v[200:203], v4, s[40:43], s69 offen offset:1024 nt
    s_waitcnt vmcnt(2)
    buffer_load_dwordx4 v[204:207], v4, s[40:43], s69 offen offset:3072 nt
    s_lshl_b32 s65, s57, 3
    v_add_f32 v31, v20, v21
    v_add_f32 v31, v31, v22
    v_add_f32 v31, v31, v23
    v_add_f32 v31, v31, v24
    v_add_f32 v31, v31, v25
    v_add_f32 v31, v31, v26
    v_add_f32 v31, v31, v27
    v_cvt_pk_bf16_f32 v20, v20, v20
    v_cvt_pk_bf16_f32 v21, v21, v21
    v_cvt_pk_bf16_f32 v22, v22, v22
    v_cvt_pk_bf16_f32 v23, v23, v23
    v_cvt_pk_bf16_f32 v24, v24, v24
    v_cvt_pk_bf16_f32 v25, v25, v25
    v_cvt_pk_bf16_f32 v26, v26, v26
    v_cvt_pk_bf16_f32 v27, v27, v27
    s_nop 1
    v_add_f32_dpp v31, v31, v31 row_ror:8 row_mask:0xf bank_mask:0xf
    s_nop 1
    v_add_f32_dpp v31, v31, v31 row_ror:4 row_mask:0xf bank_mask:0xf
    v_mov_b32 v32, v31
    s_nop 1
    v_permlane16_swap_b32 v31, v32
    v_add_f32 v31, v31, v32
    v_mov_b32 v32, v31
    s_nop 1
    v_permlane32_swap_b32 v31, v32
    v_add_f32 v31, v31, v32
    v_mov_b32 v5, s65
    ds_write_b64 v5, v[30:31] offset:14336
    v_mov_b32 v8, 0x80
    v_xor_b32 v8, s59, v8
    v_mov_b32 v9, 0x80
    v_xor_b32 v9, s60, v9
    v_mov_b32 v10, 0x80
    v_xor_b32 v10, s61, v10
    v_mov_b32 v11, 0x80
    v_xor_b32 v11, s62, v11
    v_bfe_u32 v6, v1, 3, 1
    v_bfe_u32 v147, v1, 2, 1
    v_and_b32 v7, 3, v1
    v_lshlrev_b32 v133, 3, v1
    v_lshlrev_b32 v166, 4, v1
    v_and_b32 v154, 0x70, v166
    v_lshl_add_u32 v29, v7, 1, v6
    v_and_b32 v5, 1, v2
    v_lshl_add_u32 v29, v5, 3, v29
    v_lshrrev_b32 v5, 1, v2
    v_lshl_add_u32 v29, v5, 5, v29
    v_lshlrev_b32 v134, 1, v29
    v_lshl_add_u32 v122, v147, 10, v134
    s_lshl_b32 s65, s57, 7
    v_add_u32 v122, s65, v122
    v_lshl_add_u32 v29, v147, 4, v29
    v_lshlrev_b32 v167, 3, v29
    s_lshl_b32 s65, s57, 8
    v_lshl_add_u32 v155, v29, 2, s65
    s_lshr_b32 s65, s53, 3
    s_and_b32 s66, s53, 4
    s_add_u32 s65, s65, s66
    s_and_b32 s66, s53, 3
    s_lshl3_add_u32 s66, s65, s66
    s_lshl_b32 s66, s66, 5
    v_and_b32 v29, 7, v1
    v_lshl_add_u32 v123, v5, 5, v29
    v_lshl_add_u32 v123, v123, 2, s66
    v_and_b32 v5, 1, v2
    v_lshl_add_u32 v123, v5, 1, v123
    s_and_b32 s66, s53, 1
    s_lshl3_add_u32 s65, s65, s66
    s_lshl_b32 s65, s65, 4
    s_and_b32 s66, s53, 2
    s_lshl_b32 s66, s66, 9
    s_add_u32 s65, s65, s66
    v_lshl_add_u32 v141, v2, 4, v29
    v_lshl_add_u32 v141, v141, 1, s65
    v_lshlrev_b32 v135, 4, v3
    v_lshl_add_u32 v135, v2, 10, v135
    s_and_b32 s65, s57, 6
    s_add_u32 s65, s65, s57
    s_lshl_b32 s65, s65, 12
    s_add_u32 s65, s65, 65536
    v_add_u32 v135, s65, v135
    s_lshl_b32 s65, s57, 9
    v_lshlrev_b32 v146, 5, v3
    v_lshl_add_u32 v146, v2, 4, v146
    v_add_u32 v146, s65, v146
    s_lshl2_add_u32 s66, s54, 0
    s_lshl1_add_u32 s66, s66, s56
    s_lshl1_add_u32 s66, s66, s55
    s_lshl_b32 s66, s66, 9
    s_add_u32 s66, s66, 262144
    v_add_u32 v128, s66, v133
    s_xor_b32 s66, s58, 0x80808080
    v_and_b32 v29, 1, v1
    v_lshlrev_b32 v29, 4, v29
    v_lshrrev_b32 v131, v29, s66
    v_and_b32 v130, v28, v131
    v_bfe_u32 v131, v131, 8, 8
    v_add_u32 v137, s65, v133
    v_mul_u32_u24 v120, 0xaaaa, v6
    v_add_u32 v120, 0x4444, v120
    v_mad_u32_u24 v134, v147, 12, v6
    v_lshlrev_b32 v134, 9, v134
    v_lshl_add_u32 v134, v2, 6, v134
    v_lshl_add_u32 v134, v7, 4, v134
    s_and_b32 s66, s57, 1
    s_lshl_b32 s66, s66, 8
    s_lshr_b32 s65, s57, 1
    s_lshl_b32 s65, s65, 13
    s_add_u32 s66, s66, s65
    s_lshl_b32 s65, s52, 15
    s_add_u32 s66, s66, s65
    s_add_u32 s66, s66, 262144
    v_add_u32 v134, s66, v134
    v_and_b32 v136, 0x1f0, v167
    v_lshl_add_u32 v136, v6, 11, v136
    s_and_b32 s65, s79, 6
    s_add_u32 s65, s65, s79
    s_lshl_b32 s65, s65, 12
    s_add_u32 s65, s65, 65536
    s_lshl_b32 s66, s52, 7
    s_add_u32 s65, s65, s66
    v_lshl_add_u32 v142, v2, 10, v154
    v_lshl_add_u32 v142, v6, 13, v142
    v_add_u32 v142, s65, v142
    s_waitcnt vmcnt(2)
    s_xor_b32 s69, s68, 65536
    buffer_load_dwordx4 v[208:211], v4, s[40:43], s69 offen offset:0 nt
    s_waitcnt vmcnt(2)
    buffer_load_dwordx4 v[212:215], v4, s[40:43], s69 offen offset:2048 nt
    s_waitcnt vmcnt(2)
    buffer_load_dwordx4 v[216:219], v4, s[40:43], s69 offen offset:1024 nt
    s_cmp_lg_u32 s57, 0
    s_cbranch_scc1 L_mpx_skip
    v_and_b32 v5, 56, v133
    s_mov_b32 s64, 0x200000
L_mlx_spin:
    ds_read_b64 v[152:153], v5 offset:14336
    s_sub_u32 s64, s64, 1
    s_cbranch_scc1 L_mlx_go
    s_waitcnt lgkmcnt(0)
    v_cmp_eq_u32 vcc, -1, v153
    s_cbranch_vccnz L_mlx_spin
L_mlx_go:
    s_waitcnt lgkmcnt(0)
    s_nop 1
    v_max_f32_dpp v148, v152, v152 quad_perm:[1,0,3,2] row_mask:0xf bank_mask:0xf
    s_nop 1
    v_max_f32_dpp v148, v148, v148 quad_perm:[2,3,0,1] row_mask:0xf bank_mask:0xf
    s_nop 1
    v_max_f32_dpp v148, v148, v148 row_half_mirror row_mask:0xf bank_mask:0xf
    v_sub_f32 v149, v152, v148
    v_mul_f32 v149, 0x3fb8aa3b, v149
    v_exp_f32 v149, v149
    v_mov_b32 v150, 0
    v_mul_f32 v149, v149, v153
    v_mov_b32 v151, 0
    s_lshl_b32 s65, s70, 7
    v_add_f32_dpp v149, v149, v149 quad_perm:[1,0,3,2] row_mask:0xf bank_mask:0xf
    s_nop 1
    v_add_f32_dpp v149, v149, v149 quad_perm:[2,3,0,1] row_mask:0xf bank_mask:0xf
    s_nop 1
    v_add_f32_dpp v149, v149, v149 row_half_mirror row_mask:0xf bank_mask:0xf
    s_nop 1
    s_add_u32 s65, s65, 655360
    v_bfi_b32 v148, v28, s59, v148
    v_bfi_b32 v149, v28, s60, v149
    v_bfi_b32 v150, v28, s61, v150
    v_bfi_b32 v151, v28, s62, v151
    s_mov_b64 exec, 0xff
    s_cmp_eq_u32 s63, 0
    s_cbranch_scc1 L_mlx_alt
    buffer_store_dwordx4 v[148:151], v166, s[44:47], s65 offen
    s_branch L_mlx_pub
L_mlx_alt:
    buffer_store_dwordx4 v[148:151], v166, s[44:47], s65 offen sc1
L_mlx_pub:
    s_mov_b64 exec, -1
L_mpx_skip:
    v_and_b32_dpp v32, v20, v12 row_newbcast:0 row_mask:0xf bank_mask:0xf
    v_and_b32_dpp v33, v20, v13 row_newbcast:0 row_mask:0xf bank_mask:0xf
    v_and_b32_dpp v34, v20, v14 row_newbcast:0 row_mask:0xf bank_mask:0xf
    v_and_b32_dpp v35, v20, v15 row_newbcast:0 row_mask:0xf bank_mask:0xf
    v_and_b32_dpp v36, v20, v12 row_newbcast:8 row_mask:0xf bank_mask:0xf
    v_and_b32_dpp v37, v20, v13 row_newbcast:8 row_mask:0xf bank_mask:0xf
    v_and_b32_dpp v38, v20, v14 row_newbcast:8 row_mask:0xf bank_mask:0xf
    v_and_b32_dpp v39, v20, v15 row_newbcast:8 row_mask:0xf bank_mask:0xf
    v_and_b32_dpp v40, v20, v12 row_newbcast:4 row_mask:0xf bank_mask:0xf
    v_and_b32_dpp v41, v20, v13 row_newbcast:4 row_mask:0xf bank_mask:0xf
    v_and_b32_dpp v42, v20, v14 row_newbcast:4 row_mask:0xf bank_mask:0xf
    v_and_b32_dpp v43, v20, v15 row_newbcast:4 row_mask:0xf bank_mask:0xf
    v_and_b32_dpp v44, v20, v12 row_newbcast:12 row_mask:0xf bank_mask:0xf
    v_and_b32_dpp v45, v20, v13 row_newbcast:12 row_mask:0xf bank_mask:0xf
    v_and_b32_dpp v46, v20, v14 row_newbcast:12 row_mask:0xf bank_mask:0xf
    v_and_b32_dpp v47, v20, v15 row_newbcast:12 row_mask:0xf bank_mask:0xf
    v_mfma_f32_16x16x32_bf16 v[16:19], v[32:35], v[176:179], 0
    v_mfma_f32_16x16x32_bf16 v[16:19], v[36:39], v[180:183], v[16:19]
    v_mfma_f32_16x16x32_bf16 v[16:19], v[40:43], v[184:187], v[16:19]
    v_mfma_f32_16x16x32_bf16 v[16:19], v[44:47], v[188:191], v[16:19]
    v_and_b32_dpp v32, v21, v12 row_newbcast:0 row_mask:0xf bank_mask:0xf
    v_and_b32_dpp v33, v21, v13 row_newbcast:0 row_mask:0xf bank_mask:0xf
    v_and_b32_dpp v34, v21, v14 row_newbcast:0 row_mask:0xf bank_mask:0xf
    v_and_b32_dpp v35, v21, v15 row_newbcast:0 row_mask:0xf bank_mask:0xf
    v_and_b32_dpp v36, v21, v12 row_newbcast:8 row_mask:0xf bank_mask:0xf
    v_and_b32_dpp v37, v21, v13 row_newbcast:8 row_mask:0xf bank_mask:0xf
    v_and_b32_dpp v38, v21, v14 row_newbcast:8 row_mask:0xf bank_mask:0xf
    v_and_b32_dpp v39, v21, v15 row_newbcast:8 row_mask:0xf bank_mask:0xf
    v_and_b32_dpp v40, v21, v12 row_newbcast:4 row_mask:0xf bank_mask:0xf
    v_and_b32_dpp v41, v21, v13 row_newbcast:4 row_mask:0xf bank_mask:0xf
    v_and_b32_dpp v42, v21, v14 row_newbcast:4 row_mask:0xf bank_mask:0xf
    v_and_b32_dpp v43, v21, v15 row_newbcast:4 row_mask:0xf bank_mask:0xf
    v_and_b32_dpp v44, v21, v12 row_newbcast:12 row_mask:0xf bank_mask:0xf
    v_and_b32_dpp v45, v21, v13 row_newbcast:12 row_mask:0xf bank_mask:0xf
    v_and_b32_dpp v46, v21, v14 row_newbcast:12 row_mask:0xf bank_mask:0xf
    v_and_b32_dpp v47, v21, v15 row_newbcast:12 row_mask:0xf bank_mask:0xf
    v_mfma_f32_16x16x32_bf16 v[16:19], v[32:35], v[192:195], v[16:19]
    v_mfma_f32_16x16x32_bf16 v[16:19], v[36:39], v[196:199], v[16:19]
    v_mfma_f32_16x16x32_bf16 v[16:19], v[40:43], v[200:203], v[16:19]
    v_mfma_f32_16x16x32_bf16 v[16:19], v[44:47], v[204:207], v[16:19]
    s_waitcnt vmcnt(2)
    buffer_load_dwordx4 v[220:223], v4, s[40:43], s69 offen offset:3072 nt
    s_waitcnt vmcnt(2)
    s_xor_b32 s69, s68, 98304
    buffer_load_dwordx4 v[224:227], v4, s[40:43], s69 offen offset:0 nt
    s_waitcnt vmcnt(2)
    buffer_load_dwordx4 v[228:231], v4, s[40:43], s69 offen offset:2048 nt
    s_waitcnt vmcnt(2)
    buffer_load_dwordx4 v[232:235], v4, s[40:43], s69 offen offset:1024 nt
    s_waitcnt vmcnt(2)
    buffer_load_dwordx4 v[236:239], v4, s[40:43], s69 offen offset:3072 nt
    s_waitcnt vmcnt(2)
    s_xor_b32 s69, s68, 131072
    buffer_load_dwordx4 v[240:243], v4, s[40:43], s69 offen offset:0 nt
    v_and_b32_dpp v32, v22, v12 row_newbcast:0 row_mask:0xf bank_mask:0xf
    v_and_b32_dpp v33, v22, v13 row_newbcast:0 row_mask:0xf bank_mask:0xf
    v_and_b32_dpp v34, v22, v14 row_newbcast:0 row_mask:0xf bank_mask:0xf
    v_and_b32_dpp v35, v22, v15 row_newbcast:0 row_mask:0xf bank_mask:0xf
    v_and_b32_dpp v36, v22, v12 row_newbcast:8 row_mask:0xf bank_mask:0xf
    v_and_b32_dpp v37, v22, v13 row_newbcast:8 row_mask:0xf bank_mask:0xf
    v_and_b32_dpp v38, v22, v14 row_newbcast:8 row_mask:0xf bank_mask:0xf
    v_and_b32_dpp v39, v22, v15 row_newbcast:8 row_mask:0xf bank_mask:0xf
    v_and_b32_dpp v40, v22, v12 row_newbcast:4 row_mask:0xf bank_mask:0xf
    v_and_b32_dpp v41, v22, v13 row_newbcast:4 row_mask:0xf bank_mask:0xf
    v_and_b32_dpp v42, v22, v14 row_newbcast:4 row_mask:0xf bank_mask:0xf
    v_and_b32_dpp v43, v22, v15 row_newbcast:4 row_mask:0xf bank_mask:0xf
    v_and_b32_dpp v44, v22, v12 row_newbcast:12 row_mask:0xf bank_mask:0xf
    v_and_b32_dpp v45, v22, v13 row_newbcast:12 row_mask:0xf bank_mask:0xf
    v_and_b32_dpp v46, v22, v14 row_newbcast:12 row_mask:0xf bank_mask:0xf
    v_and_b32_dpp v47, v22, v15 row_newbcast:12 row_mask:0xf bank_mask:0xf
    v_mfma_f32_16x16x32_bf16 v[16:19], v[32:35], v[208:211], v[16:19]
    v_mfma_f32_16x16x32_bf16 v[16:19], v[36:39], v[212:215], v[16:19]
    v_mfma_f32_16x16x32_bf16 v[16:19], v[40:43], v[216:219], v[16:19]
    v_mfma_f32_16x16x32_bf16 v[16:19], v[44:47], v[220:223], v[16:19]
    s_waitcnt vmcnt(2)
    buffer_load_dwordx4 v[244:247], v4, s[40:43], s69 offen offset:2048 nt
    s_waitcnt vmcnt(2)
    buffer_load_dwordx4 v[248:251], v4, s[40:43], s69 offen offset:1024 nt
    s_waitcnt vmcnt(2)
    buffer_load_dwordx4 v[252:255], v4, s[40:43], s69 offen offset:3072 nt
    s_cmp_lg_u32 s57, 0
    s_cbranch_scc1 L_mgx_skip
    v_and_b32 v145, 3, v1
    v_lshlrev_b32 v145, 7, v145
    s_lshr_b32 s80, s70, 2
    s_lshl_b32 s80, s80, 9
    s_add_u32 s80, s80, 655360
    s_mov_b64 exec, 0xff
    buffer_load_dwordx4 v[148:151], v145, s[44:47], s80 offen sc1
    s_mov_b64 exec, -1
L_mgx_skip:
    v_and_b32_dpp v32, v23, v12 row_newbcast:0 row_mask:0xf bank_mask:0xf
    v_and_b32_dpp v33, v23, v13 row_newbcast:0 row_mask:0xf bank_mask:0xf
    v_and_b32_dpp v34, v23, v14 row_newbcast:0 row_mask:0xf bank_mask:0xf
    v_and_b32_dpp v35, v23, v15 row_newbcast:0 row_mask:0xf bank_mask:0xf
    v_and_b32_dpp v36, v23, v12 row_newbcast:8 row_mask:0xf bank_mask:0xf
    v_and_b32_dpp v37, v23, v13 row_newbcast:8 row_mask:0xf bank_mask:0xf
    v_and_b32_dpp v38, v23, v14 row_newbcast:8 row_mask:0xf bank_mask:0xf
    v_and_b32_dpp v39, v23, v15 row_newbcast:8 row_mask:0xf bank_mask:0xf
    v_and_b32_dpp v40, v23, v12 row_newbcast:4 row_mask:0xf bank_mask:0xf
    v_and_b32_dpp v41, v23, v13 row_newbcast:4 row_mask:0xf bank_mask:0xf
    v_and_b32_dpp v42, v23, v14 row_newbcast:4 row_mask:0xf bank_mask:0xf
    v_and_b32_dpp v43, v23, v15 row_newbcast:4 row_mask:0xf bank_mask:0xf
    v_and_b32_dpp v44, v23, v12 row_newbcast:12 row_mask:0xf bank_mask:0xf
    v_and_b32_dpp v45, v23, v13 row_newbcast:12 row_mask:0xf bank_mask:0xf
    v_and_b32_dpp v46, v23, v14 row_newbcast:12 row_mask:0xf bank_mask:0xf
    v_and_b32_dpp v47, v23, v15 row_newbcast:12 row_mask:0xf bank_mask:0xf
    v_mfma_f32_16x16x32_bf16 v[16:19], v[32:35], v[224:227], v[16:19]
    v_mfma_f32_16x16x32_bf16 v[16:19], v[36:39], v[228:231], v[16:19]
    v_mfma_f32_16x16x32_bf16 v[16:19], v[40:43], v[232:235], v[16:19]
    v_mfma_f32_16x16x32_bf16 v[16:19], v[44:47], v[236:239], v[16:19]
    s_waitcnt vmcnt(2)
    s_xor_b32 s69, s68, 163840
    buffer_load_dwordx4 v[176:179], v4, s[40:43], s69 offen offset:0 nt
    s_waitcnt vmcnt(2)
    buffer_load_dwordx4 v[180:183], v4, s[40:43], s69 offen offset:2048 nt
    s_waitcnt vmcnt(2)
    buffer_load_dwordx4 v[184:187], v4, s[40:43], s69 offen offset:1024 nt
    buffer_load_dwordx4 v[188:191], v4, s[40:43], s69 offen offset:3072 nt
    s_cmp_lg_u32 s57, 0
    s_cbranch_scc1 L_mfx_skip
    s_waitcnt vmcnt(4)
    s_mov_b32 s64, 0x20000
L_mx_chk:
    s_mov_b64 exec, 0xff
    v_xor_b32 v148, s59, v148
    v_xor_b32 v149, s60, v149
    v_xor_b32 v150, s61, v150
    v_xor_b32 v151, s62, v151
    v_or3_b32 v5, v148, v149, v150
    v_or_b32 v5, v5, v151
    v_cmp_ne_u32_sdwa vcc, v5, 0 src0_sel:BYTE_0 src1_sel:DWORD
    s_mov_b64 exec, -1
    s_cbranch_vccnz L_mx_again
L_mx_ok:
    v_max_f32_dpp v150, v148, v148 quad_perm:[1,0,3,2] row_mask:0xf bank_mask:0xf
    s_nop 1
    v_max_f32_dpp v150, v150, v150 quad_perm:[2,3,0,1] row_mask:0xf bank_mask:0xf
    v_sub_f32 v148, v148, v150
    v_sub_f32 v151, v152, v150
    v_mul_f32 v148, 0x3fb8aa3b, v148
    v_mul_f32 v151, 0x3fb8aa3b, v151
    v_exp_f32 v148, v148
    v_exp_f32 v151, v151
    v_mul_f32 v149, v149, v148
    s_nop 1
    v_add_f32_dpp v149, v149, v149 quad_perm:[1,0,3,2] row_mask:0xf bank_mask:0xf
    s_nop 1
    v_add_f32_dpp v149, v149, v149 quad_perm:[2,3,0,1] row_mask:0xf bank_mask:0xf
    v_rcp_f32 v149, v149
    s_nop 0
    v_mul_f32 v151, v151, v149
    s_nop 0
    v_readlane_b32 s65, v151, 0
    s_nop 1
    v_mov_b32 v112, s65
    v_readlane_b32 s65, v151, 1
    s_nop 1
    v_mov_b32 v113, s65
    v_readlane_b32 s65, v151, 2
    s_nop 1
    v_mov_b32 v114, s65
    v_readlane_b32 s65, v151, 3
    s_nop 1
    v_mov_b32 v115, s65
    v_readlane_b32 s65, v151, 4
    s_nop 1
    v_mov_b32 v116, s65
    v_readlane_b32 s65, v151, 5
    s_nop 1
    v_mov_b32 v117, s65
    v_readlane_b32 s65, v151, 6
    s_nop 1
    v_mov_b32 v118, s65
    v_readlane_b32 s65, v151, 7
    s_nop 1
    v_mov_b32 v119, s65
L_mfx_skip:
    v_and_b32_dpp v32, v24, v12 row_newbcast:0 row_mask:0xf bank_mask:0xf
    v_and_b32_dpp v33, v24, v13 row_newbcast:0 row_mask:0xf bank_mask:0xf
    v_and_b32_dpp v34, v24, v14 row_newbcast:0 row_mask:0xf bank_mask:0xf
    v_and_b32_dpp v35, v24, v15 row_newbcast:0 row_mask:0xf bank_mask:0xf
    v_and_b32_dpp v36, v24, v12 row_newbcast:8 row_mask:0xf bank_mask:0xf
    v_and_b32_dpp v37, v24, v13 row_newbcast:8 row_mask:0xf bank_mask:0xf
    v_and_b32_dpp v38, v24, v14 row_newbcast:8 row_mask:0xf bank_mask:0xf
    v_and_b32_dpp v39, v24, v15 row_newbcast:8 row_mask:0xf bank_mask:0xf
    v_and_b32_dpp v40, v24, v12 row_newbcast:4 row_mask:0xf bank_mask:0xf
    v_and_b32_dpp v41, v24, v13 row_newbcast:4 row_mask:0xf bank_mask:0xf
    v_and_b32_dpp v42, v24, v14 row_newbcast:4 row_mask:0xf bank_mask:0xf
    v_and_b32_dpp v43, v24, v15 row_newbcast:4 row_mask:0xf bank_mask:0xf
    v_and_b32_dpp v44, v24, v12 row_newbcast:12 row_mask:0xf bank_mask:0xf
    v_and_b32_dpp v45, v24, v13 row_newbcast:12 row_mask:0xf bank_mask:0xf
    v_and_b32_dpp v46, v24, v14 row_newbcast:12 row_mask:0xf bank_mask:0xf
    v_and_b32_dpp v47, v24, v15 row_newbcast:12 row_mask:0xf bank_mask:0xf
    v_mfma_f32_16x16x32_bf16 v[16:19], v[32:35], v[240:243], v[16:19]
    v_mfma_f32_16x16x32_bf16 v[16:19], v[36:39], v[244:247], v[16:19]
    v_mfma_f32_16x16x32_bf16 v[16:19], v[40:43], v[248:251], v[16:19]
    v_mfma_f32_16x16x32_bf16 v[16:19], v[44:47], v[252:255], v[16:19]
    s_waitcnt vmcnt(3)
    s_xor_b32 s69, s68, 196608
    buffer_load_dwordx4 v[192:195], v4, s[40:43], s69 offen offset:0 nt
    s_waitcnt vmcnt(3)
    buffer_load_dwordx4 v[196:199], v4, s[40:43], s69 offen offset:2048 nt
    s_waitcnt vmcnt(3)
    buffer_load_dwordx4 v[200:203], v4, s[40:43], s69 offen offset:1024 nt
    s_waitcnt vmcnt(3)
    buffer_load_dwordx4 v[204:207], v4, s[40:43], s69 offen offset:3072 nt
    v_and_b32_dpp v32, v25, v12 row_newbcast:0 row_mask:0xf bank_mask:0xf
    v_and_b32_dpp v33, v25, v13 row_newbcast:0 row_mask:0xf bank_mask:0xf
    v_and_b32_dpp v34, v25, v14 row_newbcast:0 row_mask:0xf bank_mask:0xf
    v_and_b32_dpp v35, v25, v15 row_newbcast:0 row_mask:0xf bank_mask:0xf
    v_and_b32_dpp v36, v25, v12 row_newbcast:8 row_mask:0xf bank_mask:0xf
    v_and_b32_dpp v37, v25, v13 row_newbcast:8 row_mask:0xf bank_mask:0xf
    v_and_b32_dpp v38, v25, v14 row_newbcast:8 row_mask:0xf bank_mask:0xf
    v_and_b32_dpp v39, v25, v15 row_newbcast:8 row_mask:0xf bank_mask:0xf
    v_and_b32_dpp v40, v25, v12 row_newbcast:4 row_mask:0xf bank_mask:0xf
    v_and_b32_dpp v41, v25, v13 row_newbcast:4 row_mask:0xf bank_mask:0xf
    v_and_b32_dpp v42, v25, v14 row_newbcast:4 row_mask:0xf bank_mask:0xf
    v_and_b32_dpp v43, v25, v15 row_newbcast:4 row_mask:0xf bank_mask:0xf
    v_and_b32_dpp v44, v25, v12 row_newbcast:12 row_mask:0xf bank_mask:0xf
    v_and_b32_dpp v45, v25, v13 row_newbcast:12 row_mask:0xf bank_mask:0xf
    v_and_b32_dpp v46, v25, v14 row_newbcast:12 row_mask:0xf bank_mask:0xf
    v_and_b32_dpp v47, v25, v15 row_newbcast:12 row_mask:0xf bank_mask:0xf
    v_mfma_f32_16x16x32_bf16 v[16:19], v[32:35], v[176:179], v[16:19]
    v_mfma_f32_16x16x32_bf16 v[16:19], v[36:39], v[180:183], v[16:19]
    v_mfma_f32_16x16x32_bf16 v[16:19], v[40:43], v[184:187], v[16:19]
    v_mfma_f32_16x16x32_bf16 v[16:19], v[44:47], v[188:191], v[16:19]
    s_waitcnt vmcnt(3)
    s_xor_b32 s69, s68, 229376
    buffer_load_dwordx4 v[208:211], v4, s[40:43], s69 offen offset:0 nt
    s_waitcnt vmcnt(3)
    buffer_load_dwordx4 v[212:215], v4, s[40:43], s69 offen offset:2048 nt
    s_waitcnt vmcnt(3)
    buffer_load_dwordx4 v[216:219], v4, s[40:43], s69 offen offset:1024 nt
    s_waitcnt vmcnt(3)
    buffer_load_dwordx4 v[220:223], v4, s[40:43], s69 offen offset:3072 nt
    v_and_b32_dpp v32, v26, v12 row_newbcast:0 row_mask:0xf bank_mask:0xf
    v_and_b32_dpp v33, v26, v13 row_newbcast:0 row_mask:0xf bank_mask:0xf
    v_and_b32_dpp v34, v26, v14 row_newbcast:0 row_mask:0xf bank_mask:0xf
    v_and_b32_dpp v35, v26, v15 row_newbcast:0 row_mask:0xf bank_mask:0xf
    v_and_b32_dpp v36, v26, v12 row_newbcast:8 row_mask:0xf bank_mask:0xf
    v_and_b32_dpp v37, v26, v13 row_newbcast:8 row_mask:0xf bank_mask:0xf
    v_and_b32_dpp v38, v26, v14 row_newbcast:8 row_mask:0xf bank_mask:0xf
    v_and_b32_dpp v39, v26, v15 row_newbcast:8 row_mask:0xf bank_mask:0xf
    v_and_b32_dpp v40, v26, v12 row_newbcast:4 row_mask:0xf bank_mask:0xf
    v_and_b32_dpp v41, v26, v13 row_newbcast:4 row_mask:0xf bank_mask:0xf
    v_and_b32_dpp v42, v26, v14 row_newbcast:4 row_mask:0xf bank_mask:0xf
    v_and_b32_dpp v43, v26, v15 row_newbcast:4 row_mask:0xf bank_mask:0xf
    v_and_b32_dpp v44, v26, v12 row_newbcast:12 row_mask:0xf bank_mask:0xf
    v_and_b32_dpp v45, v26, v13 row_newbcast:12 row_mask:0xf bank_mask:0xf
    v_and_b32_dpp v46, v26, v14 row_newbcast:12 row_mask:0xf bank_mask:0xf
    v_and_b32_dpp v47, v26, v15 row_newbcast:12 row_mask:0xf bank_mask:0xf
    v_mfma_f32_16x16x32_bf16 v[16:19], v[32:35], v[192:195], v[16:19]
    v_mfma_f32_16x16x32_bf16 v[16:19], v[36:39], v[196:199], v[16:19]
    v_mfma_f32_16x16x32_bf16 v[16:19], v[40:43], v[200:203], v[16:19]
    v_mfma_f32_16x16x32_bf16 v[16:19], v[44:47], v[204:207], v[16:19]
    v_and_b32_dpp v32, v27, v12 row_newbcast:0 row_mask:0xf bank_mask:0xf
    v_and_b32_dpp v33, v27, v13 row_newbcast:0 row_mask:0xf bank_mask:0xf
    v_and_b32_dpp v34, v27, v14 row_newbcast:0 row_mask:0xf bank_mask:0xf
    v_and_b32_dpp v35, v27, v15 row_newbcast:0 row_mask:0xf bank_mask:0xf
    v_and_b32_dpp v36, v27, v12 row_newbcast:8 row_mask:0xf bank_mask:0xf
    v_and_b32_dpp v37, v27, v13 row_newbcast:8 row_mask:0xf bank_mask:0xf
    v_and_b32_dpp v38, v27, v14 row_newbcast:8 row_mask:0xf bank_mask:0xf
    v_and_b32_dpp v39, v27, v15 row_newbcast:8 row_mask:0xf bank_mask:0xf
    v_and_b32_dpp v40, v27, v12 row_newbcast:4 row_mask:0xf bank_mask:0xf
    v_and_b32_dpp v41, v27, v13 row_newbcast:4 row_mask:0xf bank_mask:0xf
    v_and_b32_dpp v42, v27, v14 row_newbcast:4 row_mask:0xf bank_mask:0xf
    v_and_b32_dpp v43, v27, v15 row_newbcast:4 row_mask:0xf bank_mask:0xf
    v_and_b32_dpp v44, v27, v12 row_newbcast:12 row_mask:0xf bank_mask:0xf
    v_and_b32_dpp v45, v27, v13 row_newbcast:12 row_mask:0xf bank_mask:0xf
    v_and_b32_dpp v46, v27, v14 row_newbcast:12 row_mask:0xf bank_mask:0xf
    v_and_b32_dpp v47, v27, v15 row_newbcast:12 row_mask:0xf bank_mask:0xf
    s_waitcnt vmcnt(3)
    v_mfma_f32_16x16x32_bf16 v[16:19], v[32:35], v[208:211], v[16:19]
    s_mov_b32 s48, s16
    s_mov_b32 s49, s17
    s_mov_b32 s50, 4194304
    s_mov_b32 s51, 0x20000
    v_lshrrev_b32 v0, 3, v1
    v_and_b32 v5, 4, v0
    v_add_u32 v0, v5, v0
    v_mul_u32_u24 v0, 1024, v0
    v_lshlrev_b32 v5, 1, v2
    v_xor_b32 v5, v1, v5
    v_and_b32 v5, 7, v5
    v_lshl_add_u32 v0, v5, 4, v0
    s_lshl_b32 s76, s52, 19
    s_lshl_b32 s66, s57, 16
    s_add_u32 s76, s76, s66
    s_lshl_b32 s66, s79, 7
    s_add_u32 m0, s77, 16384
    s_add_u32 s76, s76, s66
    buffer_load_dwordx4 v0, s[48:51], s76 offen nt lds
    s_waitcnt vmcnt(3)
    v_mfma_f32_16x16x32_bf16 v[16:19], v[36:39], v[212:215], v[16:19]
    s_add_u32 m0, s77, 17408
    s_add_u32 s76, s76, 4096
    buffer_load_dwordx4 v0, s[48:51], s76 offen nt lds
    s_waitcnt vmcnt(3)
    v_mfma_f32_16x16x32_bf16 v[16:19], v[40:43], v[216:219], v[16:19]
    s_add_u32 m0, s77, 18432
    s_add_u32 s76, s76, 12288
    buffer_load_dwordx4 v0, s[48:51], s76 offen nt lds
    s_waitcnt vmcnt(3)
    v_mfma_f32_16x16x32_bf16 v[16:19], v[44:47], v[220:223], v[16:19]
    s_add_u32 m0, s77, 19456
    s_add_u32 s76, s76, 4096
    buffer_load_dwordx4 v0, s[48:51], s76 offen nt lds
    s_add_u32 m0, s77, 20480
    s_add_u32 s76, s76, 12288
    buffer_load_dwordx4 v0, s[48:51], s76 offen nt lds
    s_add_u32 m0, s77, 21504
    s_add_u32 s76, s76, 4096
    buffer_load_dwordx4 v0, s[48:51], s76 offen nt lds
    s_add_u32 m0, s77, 22528
    s_add_u32 s76, s76, 12288
    buffer_load_dwordx4 v0, s[48:51], s76 offen nt lds
    s_add_u32 m0, s77, 23552
    s_add_u32 s76, s76, 4096
    buffer_load_dwordx4 v0, s[48:51], s76 offen nt lds
    s_branch L_tail
L_s_f:
    s_waitcnt vmcnt(2)
    buffer_load_dwordx4 v[88:91], v4, s[36:39], s69 offen offset:1024 nt
    s_waitcnt vmcnt(2)
    buffer_load_dwordx4 v[92:95], v4, s[36:39], s69 offen offset:3072 nt
    s_waitcnt vmcnt(2)
    s_xor_b32 s69, s68, 98304
    buffer_load_dwordx4 v[96:99], v4, s[36:39], s69 offen offset:0 nt
    s_waitcnt vmcnt(2)
    buffer_load_dwordx4 v[100:103], v4, s[36:39], s69 offen offset:2048 nt
    s_waitcnt vmcnt(2)
    buffer_load_dwordx4 v[104:107], v4, s[36:39], s69 offen offset:1024 nt
    s_waitcnt vmcnt(2)
    buffer_load_dwordx4 v[108:111], v4, s[36:39], s69 offen offset:3072 nt
    s_cmp_lg_u32 s57, 0
    s_cbranch_scc1 L_xif_skip
    v_and_b32 v5, 31, v1
    v_lshlrev_b32 v5, 2, v5
    s_lshl_b32 s65, s52, 7
    s_add_u32 s65, s65, 4096
    buffer_load_dword v29, v5, s[44:47], s65 offen sc1
L_xif_skip:
    s_waitcnt vmcnt(2)
    s_xor_b32 s69, s68, 131072
    buffer_load_dwordx4 v[112:115], v4, s[36:39], s69 offen offset:0 nt
    s_waitcnt vmcnt(2)
    buffer_load_dwordx4 v[116:119], v4, s[36:39], s69 offen offset:2048 nt
    s_waitcnt vmcnt(2)
    buffer_load_dwordx4 v[120:123], v4, s[36:39], s69 offen offset:1024 nt
    buffer_load_dwordx4 v[124:127], v4, s[36:39], s69 offen offset:3072 nt
    s_cmp_lg_u32 s57, 0
    s_cbranch_scc1 L_xff_skip
    s_waitcnt vmcnt(4)
    s_xor_b32 s65, s67, 134217728
    v_cmp_eq_u32 vcc, s65, v29
    v_xor_b32 v29, s67, v29
    v_and_b32 v29, 0xf7ffffff, v29
    s_bcnt1_i32_b32 s65, vcc_lo
    v_cmp_ne_u32 vcc, 0, v29
    s_cmp_ge_u32 s65, 15
    s_cselect_b32 s65, 0, 0x2000
    s_cmp_eq_u64 vcc, 0
    s_cselect_b32 s63, 1, 0
    s_or_b32 s65, s65, s63
    v_mov_b32 v5, 14848
    v_mov_b32 v6, s65
    ds_write_b32 v5, v6
    s_cmp_eq_u32 s63, 0
    s_cbranch_scc1 L_qfarf
L_xff_skip:
    s_waitcnt vmcnt(3)
    s_xor_b32 s69, s68, 163840
    buffer_load_dwordx4 v[128:131], v4, s[36:39], s69 offen offset:0 nt
    s_waitcnt vmcnt(3)
    buffer_load_dwordx4 v[132:135], v4, s[36:39], s69 offen offset:2048 nt
    s_waitcnt vmcnt(3)
    buffer_load_dwordx4 v[136:139], v4, s[36:39], s69 offen offset:1024 nt
    s_waitcnt vmcnt(3)
    buffer_load_dwordx4 v[140:143], v4, s[36:39], s69 offen offset:3072 nt
    s_cmp_lg_u32 s57, 1
    s_cbranch_scc1 L_qif_skip
    s_lshl_b32 s78, s54, 13
    s_lshl_b32 s66, s56, 10
    s_add_u32 s78, s78, s66
    s_add_u32 s78, s78, 262144
    buffer_load_dwordx4 v[32:35], v7, s[44:47], s78 offen offset:0 sc1
    buffer_load_dwordx4 v[36:39], v7, s[44:47], s78 offen offset:1024 sc1
    buffer_load_dwordx4 v[40:43], v7, s[44:47], s78 offen offset:2048 sc1
    buffer_load_dwordx4 v[44:47], v7, s[44:47], s78 offen offset:3072 sc1
L_qif_skip:
    s_waitcnt vmcnt(3)
    s_xor_b32 s69, s68, 196608
    buffer_load_dwordx4 v[144:147], v4, s[36:39], s69 offen offset:0 nt
    s_waitcnt vmcnt(3)
    buffer_load_dwordx4 v[148:151], v4, s[36:39], s69 offen offset:2048 nt
    s_waitcnt vmcnt(3)
    buffer_load_dwordx4 v[152:155], v4, s[36:39], s69 offen offset:1024 nt
    s_waitcnt vmcnt(3)
    buffer_load_dwordx4 v[156:159], v4, s[36:39], s69 offen offset:3072 nt
    s_cmp_lg_u32 s57, 1
    s_cbranch_scc1 L_qff_skip
    s_waitcnt vmcnt(4)
    s_mov_b32 s64, 0x20000
L_qf_chk:
    v_xor_b32 v32, s59, v32
    v_xor_b32 v33, s60, v33
    v_xor_b32 v34, s61, v34
    v_xor_b32 v35, s62, v35
    v_or3_b32 v30, v32, v33, v34
    v_xor_b32 v36, s59, v36
    v_xor_b32 v37, s60, v37
    v_xor_b32 v38, s61, v38
    v_xor_b32 v39, s62, v39
    v_or3_b32 v30, v30, v35, v36
    v_or3_b32 v30, v30, v37, v38
    v_xor_b32 v40, s59, v40
    v_xor_b32 v41, s60, v41
    v_xor_b32 v42, s61, v42
    v_xor_b32 v43, s62, v43
    v_or3_b32 v30, v30, v39, v40
    v_or3_b32 v30, v30, v41, v42
    v_xor_b32 v44, s59, v44
    v_xor_b32 v45, s60, v45
    v_xor_b32 v46, s61, v46
    v_xor_b32 v47, s62, v47
    v_or3_b32 v30, v30, v43, v44
    v_or3_b32 v30, v30, v45, v46
    v_or_b32 v30, v30, v47
    v_cmp_ne_u32_sdwa vcc, v30, 0 src0_sel:BYTE_0 src1_sel:DWORD
    s_cbranch_vccnz L_qf_again
L_qf_ok:
    v_pk_add_f32 v[32:33], v[32:33], v[40:41]
    v_pk_add_f32 v[34:35], v[34:35], v[42:43]
    v_pk_add_f32 v[36:37], v[36:37], v[44:45]
    v_pk_add_f32 v[38:39], v[38:39], v[46:47]
    v_pk_add_f32 v[32:33], v[32:33], v[36:37]
    v_pk_add_f32 v[34:35], v[34:35], v[38:39]
    v_and_b32 v5, 1, v2
    v_lshlrev_b32 v5, 3, v5
    v_permlane32_swap_b32 v32, v34
    v_permlane32_swap_b32 v33, v35
    v_lshl_add_u32 v5, v3, 4, v5
    v_lshrrev_b32 v6, 1, v2
    v_pk_add_f32 v[32:33], v[32:33], v[34:35]
    v_lshl_add_u32 v5, v6, 2, v5
    v_cvt_pk_bf16_f32 v32, v32, v33
    ds_write_b32 v5, v32 offset:14592
L_qff_skip:
    s_waitcnt vmcnt(3)
    s_xor_b32 s69, s68, 229376
    buffer_load_dwordx4 v[160:163], v4, s[36:39], s69 offen offset:0 nt
    s_waitcnt vmcnt(3)
    buffer_load_dwordx4 v[164:167], v4, s[36:39], s69 offen offset:2048 nt
    s_waitcnt vmcnt(3)
    buffer_load_dwordx4 v[168:171], v4, s[36:39], s69 offen offset:1024 nt
    s_waitcnt vmcnt(3)
    buffer_load_dwordx4 v[172:175], v4, s[36:39], s69 offen offset:3072 nt
    v_lshlrev_b32 v5, 4, v3
    s_mov_b32 s64, 0x200000
L_qrf_spin:
    ds_read_b128 v[8:11], v5 offset:14592
    s_sub_u32 s64, s64, 1
    s_cbranch_scc1 L_qrf_go
    s_waitcnt lgkmcnt(0)
    v_max3_u32 v6, v8, v9, v10
    v_max_u32 v6, v6, v11
    v_cmp_eq_u32 vcc, -1, v6
    s_cbranch_vccnz L_qrf_spin
L_qrf_go:
    s_waitcnt lgkmcnt(0)
    v_dot2_f32_bf16 v32, v48, v8, 0
    v_dot2_f32_bf16 v33, v52, v8, 0
    v_dot2_f32_bf16 v34, v56, v8, 0
    v_dot2_f32_bf16 v35, v60, v8, 0
    v_dot2_f32_bf16 v32, v49, v9, v32
    v_dot2_f32_bf16 v33, v53, v9, v33
    v_dot2_f32_bf16 v34, v57, v9, v34
    v_dot2_f32_bf16 v35, v61, v9, v35
    v_dot2_f32_bf16 v32, v50, v10, v32
    v_dot2_f32_bf16 v33, v54, v10, v33
    v_dot2_f32_bf16 v34, v58, v10, v34
    v_dot2_f32_bf16 v35, v62, v10, v35
    v_dot2_f32_bf16 v32, v51, v11, v32
    v_dot2_f32_bf16 v33, v55, v11, v33
    v_dot2_f32_bf16 v34, v59, v11, v34
    v_dot2_f32_bf16 v35, v63, v11, v35
    v_add_f32_dpp v36, v32, v32 row_ror:8 row_mask:0xf bank_mask:0x3
    v_add_f32_dpp v36, v33, v33 row_ror:8 row_mask:0xf bank_mask:0xc
    v_add_f32_dpp v37, v34, v34 row_ror:8 row_mask:0xf bank_mask:0x3
    v_add_f32_dpp v37, v35, v35 row_ror:8 row_mask:0xf bank_mask:0xc
    v_add_f32_dpp v20, v36, v36 row_shl:4 row_mask:0xf bank_mask:0x5
    s_nop 0
    v_add_f32_dpp v20, v37, v37 row_shr:4 row_mask:0xf bank_mask:0xa
    v_dot2_f32_bf16 v32, v64, v8, 0
    v_dot2_f32_bf16 v33, v68, v8, 0
    v_dot2_f32_bf16 v34, v72, v8, 0
    v_dot2_f32_bf16 v35, v76, v8, 0
    v_dot2_f32_bf16 v32, v65, v9, v32
    v_dot2_f32_bf16 v33, v69, v9, v33
    v_dot2_f32_bf16 v34, v73, v9, v34
    v_dot2_f32_bf16 v35, v77, v9, v35
    v_dot2_f32_bf16 v32, v66, v10, v32
    v_dot2_f32_bf16 v33, v70, v10, v33
    v_dot2_f32_bf16 v34, v74, v10, v34
    v_dot2_f32_bf16 v35, v78, v10, v35
    v_dot2_f32_bf16 v32, v67, v11, v32
    v_dot2_f32_bf16 v33, v71, v11, v33
    v_dot2_f32_bf16 v34, v75, v11, v34
    v_dot2_f32_bf16 v35, v79, v11, v35
    v_add_f32_dpp v36, v32, v32 row_ror:8 row_mask:0xf bank_mask:0x3
    v_add_f32_dpp v36, v33, v33 row_ror:8 row_mask:0xf bank_mask:0xc
    v_add_f32_dpp v37, v34, v34 row_ror:8 row_mask:0xf bank_mask:0x3
    v_add_f32_dpp v37, v35, v35 row_ror:8 row_mask:0xf bank_mask:0xc
    v_add_f32_dpp v21, v36, v36 row_shl:4 row_mask:0xf bank_mask:0x5
    s_nop 0
    v_add_f32_dpp v21, v37, v37 row_shr:4 row_mask:0xf bank_mask:0xa
    v_dot2_f32_bf16 v32, v80, v8, 0
    v_dot2_f32_bf16 v33, v84, v8, 0
    v_dot2_f32_bf16 v34, v88, v8, 0
    v_dot2_f32_bf16 v35, v92, v8, 0
    v_dot2_f32_bf16 v32, v81, v9, v32
    v_dot2_f32_bf16 v33, v85, v9, v33
    v_dot2_f32_bf16 v34, v89, v9, v34
    v_dot2_f32_bf16 v35, v93, v9, v35
    v_dot2_f32_bf16 v32, v82, v10, v32
    v_dot2_f32_bf16 v33, v86, v10, v33
    v_dot2_f32_bf16 v34, v90, v10, v34
    v_dot2_f32_bf16 v35, v94, v10, v35
    v_dot2_f32_bf16 v32, v83, v11, v32
    v_dot2_f32_bf16 v33, v87, v11, v33
    v_dot2_f32_bf16 v34, v91, v11, v34
    v_dot2_f32_bf16 v35, v95, v11, v35
    v_add_f32_dpp v36, v32, v32 row_ror:8 row_mask:0xf bank_mask:0x3
    v_add_f32_dpp v36, v33, v33 row_ror:8 row_mask:0xf bank_mask:0xc
    v_add_f32_dpp v37, v34, v34 row_ror:8 row_mask:0xf bank_mask:0x3
    v_add_f32_dpp v37, v35, v35 row_ror:8 row_mask:0xf bank_mask:0xc
    v_add_f32_dpp v22, v36, v36 row_shl:4 row_mask:0xf bank_mask:0x5
    s_nop 0
    v_add_f32_dpp v22, v37, v37 row_shr:4 row_mask:0xf bank_mask:0xa
    v_dot2_f32_bf16 v32, v96, v8, 0
    v_dot2_f32_bf16 v33, v100, v8, 0
    v_dot2_f32_bf16 v34, v104, v8, 0
    v_dot2_f32_bf16 v35, v108, v8, 0
    v_dot2_f32_bf16 v32, v97, v9, v32
    v_dot2_f32_bf16 v33, v101, v9, v33
    v_dot2_f32_bf16 v34, v105, v9, v34
    v_dot2_f32_bf16 v35, v109, v9, v35
    v_dot2_f32_bf16 v32, v98, v10, v32
    v_dot2_f32_bf16 v33, v102, v10, v33
    v_dot2_f32_bf16 v34, v106, v10, v34
    v_dot2_f32_bf16 v35, v110, v10, v35
    v_dot2_f32_bf16 v32, v99, v11, v32
    v_dot2_f32_bf16 v33, v103, v11, v33
    v_dot2_f32_bf16 v34, v107, v11, v34
    v_dot2_f32_bf16 v35, v111, v11, v35
    v_add_f32_dpp v36, v32, v32 row_ror:8 row_mask:0xf bank_mask:0x3
    v_add_f32_dpp v36, v33, v33 row_ror:8 row_mask:0xf bank_mask:0xc
    v_add_f32_dpp v37, v34, v34 row_ror:8 row_mask:0xf bank_mask:0x3
    v_add_f32_dpp v37, v35, v35 row_ror:8 row_mask:0xf bank_mask:0xc
    v_add_f32_dpp v23, v36, v36 row_shl:4 row_mask:0xf bank_mask:0x5
    s_nop 0
    v_add_f32_dpp v23, v37, v37 row_shr:4 row_mask:0xf bank_mask:0xa
    v_dot2_f32_bf16 v32, v112, v8, 0
    v_dot2_f32_bf16 v33, v116, v8, 0
    v_dot2_f32_bf16 v34, v120, v8, 0
    v_dot2_f32_bf16 v35, v124, v8, 0
    v_dot2_f32_bf16 v32, v113, v9, v32
    v_dot2_f32_bf16 v33, v117, v9, v33
    v_dot2_f32_bf16 v34, v121, v9, v34
    v_dot2_f32_bf16 v35, v125, v9, v35
    v_dot2_f32_bf16 v32, v114, v10, v32
    v_dot2_f32_bf16 v33, v118, v10, v33
    v_dot2_f32_bf16 v34, v122, v10, v34
    v_dot2_f32_bf16 v35, v126, v10, v35
    v_dot2_f32_bf16 v32, v115, v11, v32
    v_dot2_f32_bf16 v33, v119, v11, v33
    v_dot2_f32_bf16 v34, v123, v11, v34
    v_dot2_f32_bf16 v35, v127, v11, v35
    v_add_f32_dpp v36, v32, v32 row_ror:8 row_mask:0xf bank_mask:0x3
    v_add_f32_dpp v36, v33, v33 row_ror:8 row_mask:0xf bank_mask:0xc
    v_add_f32_dpp v37, v34, v34 row_ror:8 row_mask:0xf bank_mask:0x3
    v_add_f32_dpp v37, v35, v35 row_ror:8 row_mask:0xf bank_mask:0xc
    v_add_f32_dpp v24, v36, v36 row_shl:4 row_mask:0xf bank_mask:0x5
    s_nop 0
    v_add_f32_dpp v24, v37, v37 row_shr:4 row_mask:0xf bank_mask:0xa
    s_waitcnt vmcnt(3)
    s_mov_b32 s48, s20
    s_mov_b32 s49, s21
    s_mov_b32 s50, 1409024
    s_mov_b32 s51, 0x20000
    v_and_b32 v0, 2, v2
    v_and_b32 v5, 8, v1
    v_add_u32 v0, v5, v0
    v_and_b32 v5, 1, v2
    v_lshl_add_u32 v0, v0, 1, v5
    v_mul_u32_u24 v0, 2752, v0
    v_lshlrev_b32 v5, 1, v2
    v_xor_b32 v5, v1, v5
    v_and_b32 v5, 7, v5
    v_lshl_add_u32 v0, v5, 4, v0
    s_mul_i32 s76, s57, 176128
    s_lshl_b32 s66, s53, 7
    s_add_u32 m0, s77, 16384
    s_add_u32 s76, s76, s66
    buffer_load_dwordx4 v0, s[48:51], s76 offen nt lds
    s_waitcnt vmcnt(3)
    s_add_u32 m0, s77, 17408
    s_add_u32 s76, s76, 5504
    buffer_load_dwordx4 v0, s[48:51], s76 offen nt lds
    s_waitcnt vmcnt(3)
    s_add_u32 m0, s77, 18432
    s_add_u32 s76, s76, 16512
    buffer_load_dwordx4 v0, s[48:51], s76 offen nt lds
    s_waitcnt vmcnt(3)
    s_add_u32 m0, s77, 19456
    s_add_u32 s76, s76, 5504
    buffer_load_dwordx4 v0, s[48:51], s76 offen nt lds
    v_dot2_f32_bf16 v32, v128, v8, 0
    v_dot2_f32_bf16 v33, v132, v8, 0
    v_dot2_f32_bf16 v34, v136, v8, 0
    v_dot2_f32_bf16 v35, v140, v8, 0
    v_dot2_f32_bf16 v32, v129, v9, v32
    v_dot2_f32_bf16 v33, v133, v9, v33
    v_dot2_f32_bf16 v34, v137, v9, v34
    v_dot2_f32_bf16 v35, v141, v9, v35
    v_dot2_f32_bf16 v32, v130, v10, v32
    v_dot2_f32_bf16 v33, v134, v10, v33
    v_dot2_f32_bf16 v34, v138, v10, v34
    v_dot2_f32_bf16 v35, v142, v10, v35
    v_dot2_f32_bf16 v32, v131, v11, v32
    v_dot2_f32_bf16 v33, v135, v11, v33
    v_dot2_f32_bf16 v34, v139, v11, v34
    v_dot2_f32_bf16 v35, v143, v11, v35
    v_add_f32_dpp v36, v32, v32 row_ror:8 row_mask:0xf bank_mask:0x3
    v_add_f32_dpp v36, v33, v33 row_ror:8 row_mask:0xf bank_mask:0xc
    v_add_f32_dpp v37, v34, v34 row_ror:8 row_mask:0xf bank_mask:0x3
    v_add_f32_dpp v37, v35, v35 row_ror:8 row_mask:0xf bank_mask:0xc
    v_add_f32_dpp v25, v36, v36 row_shl:4 row_mask:0xf bank_mask:0x5
    s_nop 0
    v_add_f32_dpp v25, v37, v37 row_shr:4 row_mask:0xf bank_mask:0xa
    v_dot2_f32_bf16 v32, v144, v8, 0
    v_dot2_f32_bf16 v33, v148, v8, 0
    v_dot2_f32_bf16 v34, v152, v8, 0
    v_dot2_f32_bf16 v35, v156, v8, 0
    v_dot2_f32_bf16 v32, v145, v9, v32
    v_dot2_f32_bf16 v33, v149, v9, v33
    v_dot2_f32_bf16 v34, v153, v9, v34
    v_dot2_f32_bf16 v35, v157, v9, v35
    v_dot2_f32_bf16 v32, v146, v10, v32
    v_dot2_f32_bf16 v33, v150, v10, v33
    v_dot2_f32_bf16 v34, v154, v10, v34
    v_dot2_f32_bf16 v35, v158, v10, v35
    v_dot2_f32_bf16 v32, v147, v11, v32
    v_dot2_f32_bf16 v33, v151, v11, v33
    v_dot2_f32_bf16 v34, v155, v11, v34
    v_dot2_f32_bf16 v35, v159, v11, v35
    v_add_f32_dpp v36, v32, v32 row_ror:8 row_mask:0xf bank_mask:0x3
    v_add_f32_dpp v36, v33, v33 row_ror:8 row_mask:0xf bank_mask:0xc
    v_add_f32_dpp v37, v34, v34 row_ror:8 row_mask:0xf bank_mask:0x3
    v_add_f32_dpp v37, v35, v35 row_ror:8 row_mask:0xf bank_mask:0xc
    v_add_f32_dpp v26, v36, v36 row_shl:4 row_mask:0xf bank_mask:0x5
    s_nop 0
    v_add_f32_dpp v26, v37, v37 row_shr:4 row_mask:0xf bank_mask:0xa
    v_dot2_f32_bf16 v32, v160, v8, 0
    v_dot2_f32_bf16 v33, v164, v8, 0
    v_dot2_f32_bf16 v34, v168, v8, 0
    v_dot2_f32_bf16 v35, v172, v8, 0
    v_dot2_f32_bf16 v32, v161, v9, v32
    v_dot2_f32_bf16 v33, v165, v9, v33
    v_dot2_f32_bf16 v34, v169, v9, v34
    v_dot2_f32_bf16 v35, v173, v9, v35
    v_dot2_f32_bf16 v32, v162, v10, v32
    v_dot2_f32_bf16 v33, v166, v10, v33
    v_dot2_f32_bf16 v34, v170, v10, v34
    v_dot2_f32_bf16 v35, v174, v10, v35
    v_dot2_f32_bf16 v32, v163, v11, v32
    v_dot2_f32_bf16 v33, v167, v11, v33
    v_dot2_f32_bf16 v34, v171, v11, v34
    v_dot2_f32_bf16 v35, v175, v11, v35
    v_add_f32_dpp v36, v32, v32 row_ror:8 row_mask:0xf bank_mask:0x3
    v_add_f32_dpp v36, v33, v33 row_ror:8 row_mask:0xf bank_mask:0xc
    v_add_f32_dpp v37, v34, v34 row_ror:8 row_mask:0xf bank_mask:0x3
    v_add_f32_dpp v37, v35, v35 row_ror:8 row_mask:0xf bank_mask:0xc
    v_add_f32_dpp v27, v36, v36 row_shl:4 row_mask:0xf bank_mask:0x5
    s_nop 0
    v_add_f32_dpp v27, v37, v37 row_shr:4 row_mask:0xf bank_mask:0xa
    v_add_f32_dpp v20, v20, v20 quad_perm:[1,0,3,2] row_mask:0xf bank_mask:0xf
    v_add_f32_dpp v21, v21, v21 quad_perm:[1,0,3,2] row_mask:0xf bank_mask:0xf
    v_add_f32_dpp v22, v22, v22 quad_perm:[1,0,3,2] row_mask:0xf bank_mask:0xf
    v_add_f32_dpp v23, v23, v23 quad_perm:[1,0,3,2] row_mask:0xf bank_mask:0xf
    v_add_f32_dpp v24, v24, v24 quad_perm:[1,0,3,2] row_mask:0xf bank_mask:0xf
    v_add_f32_dpp v25, v25, v25 quad_perm:[1,0,3,2] row_mask:0xf bank_mask:0xf
    v_add_f32_dpp v26, v26, v26 quad_perm:[1,0,3,2] row_mask:0xf bank_mask:0xf
    v_add_f32_dpp v27, v27, v27 quad_perm:[1,0,3,2] row_mask:0xf bank_mask:0xf
    v_add_f32_dpp v20, v20, v20 quad_perm:[2,3,0,1] row_mask:0xf bank_mask:0xf
    v_add_f32_dpp v21, v21, v21 quad_perm:[2,3,0,1] row_mask:0xf bank_mask:0xf
    v_add_f32_dpp v22, v22, v22 quad_perm:[2,3,0,1] row_mask:0xf bank_mask:0xf
    v_add_f32_dpp v23, v23, v23 quad_perm:[2,3,0,1] row_mask:0xf bank_mask:0xf
    v_add_f32_dpp v24, v24, v24 quad_perm:[2,3,0,1] row_mask:0xf bank_mask:0xf
    v_add_f32_dpp v25, v25, v25 quad_perm:[2,3,0,1] row_mask:0xf bank_mask:0xf
    v_add_f32_dpp v26, v26, v26 quad_perm:[2,3,0,1] row_mask:0xf bank_mask:0xf
    v_add_f32_dpp v27, v27, v27 quad_perm:[2,3,0,1] row_mask:0xf bank_mask:0xf
    v_cvt_pk_bf16_f32 v32, v20, v21
    v_cvt_pk_bf16_f32 v33, v22, v23
    v_cvt_pk_bf16_f32 v34, v24, v25
    v_cvt_pk_bf16_f32 v35, v26, v27
    v_lshlrev_b32 v20, 16, v32
    v_and_b32 v21, 0xffff0000, v32
    v_lshlrev_b32 v22, 16, v33
    v_and_b32 v23, 0xffff0000, v33
    v_lshlrev_b32 v24, 16, v34
    v_and_b32 v25, 0xffff0000, v34
    v_lshlrev_b32 v26, 16, v35
    v_and_b32 v27, 0xffff0000, v35
    v_mul_f32 v20, 0x3db504f3, v20
    v_mul_f32 v21, 0x3db504f3, v21
    v_mul_f32 v22, 0x3db504f3, v22
    v_mul_f32 v23, 0x3db504f3, v23
    v_mul_f32 v24, 0x3db504f3, v24
    v_mul_f32 v25, 0x3db504f3, v25
    v_mul_f32 v26, 0x3db504f3, v26
    v_mul_f32 v27, 0x3db504f3, v27
    v_cvt_pk_bf16_f32 v32, v20, v21
    v_cvt_pk_bf16_f32 v33, v22, v23
    v_cvt_pk_bf16_f32 v34, v24, v25
    v_cvt_pk_bf16_f32 v35, v26, v27
    v_lshlrev_b32 v20, 16, v32
    v_and_b32 v21, 0xffff0000, v32
    v_lshlrev_b32 v22, 16, v33
    v_and_b32 v23, 0xffff0000, v33
    v_lshlrev_b32 v24, 16, v34
    v_and_b32 v25, 0xffff0000, v34
    v_lshlrev_b32 v26, 16, v35
    v_and_b32 v27, 0xffff0000, v35
    s_waitcnt vmcnt(3)
    s_add_u32 m0, s77, 20480
    s_add_u32 s76, s76, 60544
    buffer_load_dwordx4 v0, s[48:51], s76 offen nt lds
    s_waitcnt vmcnt(3)
    s_add_u32 m0, s77, 21504
    s_add_u32 s76, s76, 5504
    buffer_load_dwordx4 v0, s[48:51], s76 offen nt lds
    s_waitcnt vmcnt(3)
    s_add_u32 m0, s77, 22528
    s_add_u32 s76, s76, 16512
    buffer_load_dwordx4 v0, s[48:51], s76 offen nt lds
    s_waitcnt vmcnt(3)
    s_add_u32 m0, s77, 23552
    s_add_u32 s76, s76, 5504
    buffer_load_dwordx4 v0, s[48:51], s76 offen nt lds
    v_max3_f32 v30, v20, v21, v22
    v_max3_f32 v30, v30, v23, v24
    v_max3_f32 v30, v30, v25, v26
    v_max_f32 v30, v30, v27
    s_nop 1
    v_max_f32_dpp v30, v30, v30 row_ror:8 row_mask:0xf bank_mask:0xf
    s_nop 1
    v_max_f32_dpp v30, v30, v30 row_ror:4 row_mask:0xf bank_mask:0xf
    v_mov_b32 v32, v30
    s_nop 1
    v_permlane16_swap_b32 v30, v32
    v_max_f32 v30, v30, v32
    v_mov_b32 v32, v30
    s_nop 1
    v_permlane32_swap_b32 v30, v32
    v_max_f32 v30, v30, v32
    v_sub_f32 v20, v20, v30
    v_sub_f32 v21, v21, v30
    v_sub_f32 v22, v22, v30
    v_sub_f32 v23, v23, v30
    v_sub_f32 v24, v24, v30
    v_sub_f32 v25, v25, v30
    v_sub_f32 v26, v26, v30
    v_sub_f32 v27, v27, v30
    v_mul_f32 v20, 0x3fb8aa3b, v20
    v_mul_f32 v21, 0x3fb8aa3b, v21
    v_mul_f32 v22, 0x3fb8aa3b, v22
    v_mul_f32 v23, 0x3fb8aa3b, v23
    v_mul_f32 v24, 0x3fb8aa3b, v24
    v_mul_f32 v25, 0x3fb8aa3b, v25
    v_mul_f32 v26, 0x3fb8aa3b, v26
    v_mul_f32 v27, 0x3fb8aa3b, v27
    v_exp_f32 v20, v20
    v_exp_f32 v21, v21
    v_exp_f32 v22, v22
    v_exp_f32 v23, v23
    v_exp_f32 v24, v24
    v_exp_f32 v25, v25
    v_exp_f32 v26, v26
    v_exp_f32 v27, v27
    s_lshl_b32 s65, s57, 3
    v_add_f32 v31, v20, v21
    v_add_f32 v31, v31, v22
    v_add_f32 v31, v31, v23
    v_add_f32 v31, v31, v24
    v_add_f32 v31, v31, v25
    v_add_f32 v31, v31, v26
    v_add_f32 v31, v31, v27
    v_cvt_pk_bf16_f32 v20, v20, v20
    v_cvt_pk_bf16_f32 v21, v21, v21
    v_cvt_pk_bf16_f32 v22, v22, v22
    v_cvt_pk_bf16_f32 v23, v23, v23
    v_cvt_pk_bf16_f32 v24, v24, v24
    v_cvt_pk_bf16_f32 v25, v25, v25
    v_cvt_pk_bf16_f32 v26, v26, v26
    v_cvt_pk_bf16_f32 v27, v27, v27
    s_nop 1
    v_add_f32_dpp v31, v31, v31 row_ror:8 row_mask:0xf bank_mask:0xf
    s_nop 1
    v_add_f32_dpp v31, v31, v31 row_ror:4 row_mask:0xf bank_mask:0xf
    v_mov_b32 v32, v31
    s_nop 1
    v_permlane16_swap_b32 v31, v32
    v_add_f32 v31, v31, v32
    v_mov_b32 v32, v31
    s_nop 1
    v_permlane32_swap_b32 v31, v32
    v_add_f32 v31, v31, v32
    v_mov_b32 v5, s65
    ds_write_b64 v5, v[30:31] offset:14336
    v_bfe_u32 v6, v1, 3, 1
    v_bfe_u32 v147, v1, 2, 1
    v_and_b32 v7, 3, v1
    v_lshlrev_b32 v133, 3, v1
    v_lshlrev_b32 v166, 4, v1
    v_and_b32 v154, 0x70, v166
    v_lshl_add_u32 v29, v7, 1, v6
    v_and_b32 v5, 1, v2
    v_lshl_add_u32 v29, v5, 3, v29
    v_lshrrev_b32 v5, 1, v2
    v_lshl_add_u32 v29, v5, 5, v29
    v_lshlrev_b32 v134, 1, v29
    v_lshl_add_u32 v122, v147, 10, v134
    s_lshl_b32 s65, s57, 7
    v_add_u32 v122, s65, v122
    v_lshl_add_u32 v29, v147, 4, v29
    v_lshlrev_b32 v167, 3, v29
    s_lshl_b32 s65, s57, 8
    v_lshl_add_u32 v155, v29, 2, s65
    s_lshr_b32 s65, s53, 3
    s_and_b32 s66, s53, 4
    s_add_u32 s65, s65, s66
    s_and_b32 s66, s53, 3
    s_lshl3_add_u32 s66, s65, s66
    s_lshl_b32 s66, s66, 5
    v_and_b32 v29, 7, v1
    v_lshl_add_u32 v123, v5, 5, v29
    v_lshl_add_u32 v123, v123, 2, s66
    v_and_b32 v5, 1, v2
    v_lshl_add_u32 v123, v5, 1, v123
    s_and_b32 s66, s53, 1
    s_lshl3_add_u32 s65, s65, s66
    s_lshl_b32 s65, s65, 4
    s_and_b32 s66, s53, 2
    s_lshl_b32 s66, s66, 9
    s_add_u32 s65, s65, s66
    v_lshl_add_u32 v141, v2, 4, v29
    v_lshl_add_u32 v141, v141, 1, s65
    v_lshlrev_b32 v135, 4, v3
    v_lshl_add_u32 v135, v2, 10, v135
    s_and_b32 s65, s57, 6
    s_add_u32 s65, s65, s57
    s_lshl_b32 s65, s65, 12
    s_add_u32 s65, s65, 65536
    v_add_u32 v135, s65, v135
    s_lshl_b32 s65, s57, 9
    v_lshlrev_b32 v146, 5, v3
    v_lshl_add_u32 v146, v2, 4, v146
    v_add_u32 v146, s65, v146
    s_lshl2_add_u32 s66, s54, 0
    s_lshl1_add_u32 s66, s66, s56
    s_lshl1_add_u32 s66, s66, s55
    s_lshl_b32 s66, s66, 9
    s_add_u32 s66, s66, 262144
    v_add_u32 v128, s66, v133
    s_xor_b32 s66, s58, 0x80808080
    v_and_b32 v29, 1, v1
    v_lshlrev_b32 v29, 4, v29
    v_lshrrev_b32 v131, v29, s66
    v_and_b32 v130, v28, v131
    v_bfe_u32 v131, v131, 8, 8
    v_add_u32 v137, s65, v133
    v_mul_u32_u24 v120, 0xaaaa, v6
    v_add_u32 v120, 0x4444, v120
    v_lshlrev_b32 v139, 6, v147
    v_lshrrev_b32 v29, 3, v1
    v_mul_u32_u24 v142, 3200, v29
    s_lshl_b32 s66, s53, 7
    s_and_b32 s65, s57, 3
    s_mul_i32 s65, s65, 25600
    s_add_u32 s66, s66, s65
    s_add_u32 s66, s66, 720896
    v_add3_u32 v142, v142, v154, s66
    v_lshrrev_b32 v29, 1, v2
    v_lshl_add_u32 v138, v29, 2, v139
    s_lshl_b32 s65, s57, 3
    v_add_u32 v138, s65, v138
    v_mov_b32 v136, 0x3727c5ac
    v_mov_b32 v144, 0x3b003b00
    s_waitcnt vmcnt(3)
    buffer_load_dwordx4 v[176:179], v4, s[40:43], s68 offen offset:0 nt
    s_waitcnt vmcnt(3)
    buffer_load_dwordx4 v[180:183], v4, s[40:43], s68 offen offset:2048 nt
    s_waitcnt vmcnt(3)
    buffer_load_dwordx4 v[184:187], v4, s[40:43], s68 offen offset:1024 nt
    s_waitcnt vmcnt(3)
    buffer_load_dwordx4 v[188:191], v4, s[40:43], s68 offen offset:3072 nt
    v_bfe_u32 v6, v1, 2, 3
    v_lshrrev_b32 v7, 1, v6
    v_lshl_add_u32 v6, v6, 2, v7
    v_and_b32 v7, 3, v1
    v_lshl_add_u32 v6, v6, 2, v7
    v_lshrrev_b32 v7, 5, v1
    v_lshl_add_u32 v6, v7, 8, v6
    s_add_u32 s65, s77, 16384
    v_lshl_add_u32 v5, v6, 3, s65
    v_xor_b32 v6, 32, v5
    v_xor_b32 v7, 64, v5
    v_xor_b32 v29, 96, v5
    ds_read_b64_tr_b16 v[48:49], v5 offset:0
    ds_read_b64_tr_b16 v[50:51], v5 offset:1024
    ds_read_b64_tr_b16 v[56:57], v6 offset:0
    ds_read_b64_tr_b16 v[58:59], v6 offset:1024
    ds_read_b64_tr_b16 v[64:65], v7 offset:0
    ds_read_b64_tr_b16 v[66:67], v7 offset:1024
    ds_read_b64_tr_b16 v[72:73], v29 offset:0
    ds_read_b64_tr_b16 v[74:75], v29 offset:1024
    s_waitcnt lgkmcnt(0)
    ds_read_b64_tr_b16 v[52:53], v5 offset:4096
    ds_read_b64_tr_b16 v[54:55], v5 offset:5120
    ds_read_b64_tr_b16 v[60:61], v6 offset:4096
    ds_read_b64_tr_b16 v[62:63], v6 offset:5120
    ds_read_b64_tr_b16 v[68:69], v7 offset:4096
    ds_read_b64_tr_b16 v[70:71], v7 offset:5120
    ds_read_b64_tr_b16 v[76:77], v29 offset:4096
    ds_read_b64_tr_b16 v[78:79], v29 offset:5120
    v_mov_b32 v156, 0
    v_mov_b32 v157, 0
    v_mov_b32 v158, 0
    v_mov_b32 v159, 0
    v_mov_b32 v160, 0
    v_mov_b32 v161, 0
    v_mov_b32 v162, 0
    v_mov_b32 v163, 0
    v_mov_b32 v168, 0
    v_mov_b32 v169, 0
    v_mov_b32 v170, 0
    v_mov_b32 v171, 0
    v_mov_b32 v172, 0
    v_mov_b32 v173, 0
    v_mov_b32 v174, 0
    v_mov_b32 v175, 0
    v_mov_b32 v32, 0x3f803f80
    v_mov_b32 v33, 0x3f803f80
    v_mov_b32 v34, 0x3f803f80
    v_mov_b32 v35, 0x3f803f80
    s_waitcnt lgkmcnt(0)
    s_nop 0
    v_smfmac_f32_16x16x64_bf16 v[156:159], v[32:35], v[48:55], v120
    v_smfmac_f32_16x16x64_bf16 v[160:163], v[32:35], v[56:63], v120
    v_smfmac_f32_16x16x64_bf16 v[168:171], v[32:35], v[64:71], v120
    v_smfmac_f32_16x16x64_bf16 v[172:175], v[32:35], v[72:79], v120
    s_nop 7
    v_permlane32_swap_b32 v156, v168
    v_permlane32_swap_b32 v160, v172
    v_add_f32 v164, v156, v168
    v_add_f32 v165, v160, v172
    ds_write_b64 v137, v[164:165] offset:8192
    s_waitcnt vmcnt(3)
    s_xor_b32 s69, s68, 32768
    buffer_load_dwordx4 v[192:195], v4, s[40:43], s69 offen offset:0 nt
    s_waitcnt vmcnt(3)
    buffer_load_dwordx4 v[196:199], v4, s[40:43], s69 offen offset:2048 nt
    s_waitcnt vmcnt(3)
    buffer_load_dwordx4 v[200:203], v4, s[40:43], s69 offen offset:1024 nt
    s_waitcnt vmcnt(3)
    buffer_load_dwordx4 v[204:207], v4, s[40:43], s69 offen offset:3072 nt
    v_and_b32_dpp v32, v20, v12 row_newbcast:0 row_mask:0xf bank_mask:0xf
    v_and_b32_dpp v33, v20, v13 row_newbcast:0 row_mask:0xf bank_mask:0xf
    v_and_b32_dpp v34, v20, v14 row_newbcast:0 row_mask:0xf bank_mask:0xf
    v_and_b32_dpp v35, v20, v15 row_newbcast:0 row_mask:0xf bank_mask:0xf
    v_and_b32_dpp v36, v20, v12 row_newbcast:8 row_mask:0xf bank_mask:0xf
    v_and_b32_dpp v37, v20, v13 row_newbcast:8 row_mask:0xf bank_mask:0xf
    v_and_b32_dpp v38, v20, v14 row_newbcast:8 row_mask:0xf bank_mask:0xf
    v_and_b32_dpp v39, v20, v15 row_newbcast:8 row_mask:0xf bank_mask:0xf
    v_and_b32_dpp v40, v20, v12 row_newbcast:4 row_mask:0xf bank_mask:0xf
    v_and_b32_dpp v41, v20, v13 row_newbcast:4 row_mask:0xf bank_mask:0xf
    v_and_b32_dpp v42, v20, v14 row_newbcast:4 row_mask:0xf bank_mask:0xf
    v_and_b32_dpp v43, v20, v15 row_newbcast:4 row_mask:0xf bank_mask:0xf
    v_and_b32_dpp v44, v20, v12 row_newbcast:12 row_mask:0xf bank_mask:0xf
    v_and_b32_dpp v45, v20, v13 row_newbcast:12 row_mask:0xf bank_mask:0xf
    v_and_b32_dpp v46, v20, v14 row_newbcast:12 row_mask:0xf bank_mask:0xf
    v_and_b32_dpp v47, v20, v15 row_newbcast:12 row_mask:0xf bank_mask:0xf
    v_mfma_f32_16x16x32_bf16 v[16:19], v[32:35], v[176:179], 0
    v_mfma_f32_16x16x32_bf16 v[16:19], v[36:39], v[180:183], v[16:19]
    v_mfma_f32_16x16x32_bf16 v[16:19], v[40:43], v[184:187], v[16:19]
    v_mfma_f32_16x16x32_bf16 v[16:19], v[44:47], v[188:191], v[16:19]
    s_waitcnt vmcnt(3)
    s_xor_b32 s69, s68, 65536
    buffer_load_dwordx4 v[208:211], v4, s[40:43], s69 offen offset:0 nt
    s_waitcnt vmcnt(3)
    buffer_load_dwordx4 v[212:215], v4, s[40:43], s69 offen offset:2048 nt
    s_waitcnt vmcnt(3)
    buffer_load_dwordx4 v[216:219], v4, s[40:43], s69 offen offset:1024 nt
    s_waitcnt vmcnt(3)
    buffer_load_dwordx4 v[220:223], v4, s[40:43], s69 offen offset:3072 nt
    s_cmp_lg_u32 s57, 0
    s_cbranch_scc1 L_mpf_skip
    v_and_b32 v5, 56, v133
    s_mov_b32 s64, 0x200000
L_mlf_spin:
    ds_read_b64 v[152:153], v5 offset:14336
    s_sub_u32 s64, s64, 1
    s_cbranch_scc1 L_mlf_go
    s_waitcnt lgkmcnt(0)
    v_cmp_eq_u32 vcc, -1, v153
    s_cbranch_vccnz L_mlf_spin
L_mlf_go:
    s_waitcnt lgkmcnt(0)
    s_nop 1
    v_max_f32_dpp v148, v152, v152 quad_perm:[1,0,3,2] row_mask:0xf bank_mask:0xf
    s_nop 1
    v_max_f32_dpp v148, v148, v148 quad_perm:[2,3,0,1] row_mask:0xf bank_mask:0xf
    s_nop 1
    v_max_f32_dpp v148, v148, v148 row_half_mirror row_mask:0xf bank_mask:0xf
    v_sub_f32 v149, v152, v148
    v_mul_f32 v149, 0x3fb8aa3b, v149
    v_exp_f32 v149, v149
    v_mov_b32 v150, 0
    v_mul_f32 v149, v149, v153
    v_mov_b32 v151, 0
    s_lshl_b32 s65, s70, 7
    v_add_f32_dpp v149, v149, v149 quad_perm:[1,0,3,2] row_mask:0xf bank_mask:0xf
    s_nop 1
    v_add_f32_dpp v149, v149, v149 quad_perm:[2,3,0,1] row_mask:0xf bank_mask:0xf
    s_nop 1
    v_add_f32_dpp v149, v149, v149 row_half_mirror row_mask:0xf bank_mask:0xf
    s_nop 1
    s_add_u32 s65, s65, 655360
    v_bfi_b32 v148, v28, s59, v148
    v_bfi_b32 v149, v28, s60, v149
    v_bfi_b32 v150, v28, s61, v150
    v_bfi_b32 v151, v28, s62, v151
    s_mov_b64 exec, 0xff
    s_cmp_eq_u32 s63, 0
    s_cbranch_scc1 L_mlf_alt
    buffer_store_dwordx4 v[148:151], v166, s[44:47], s65 offen
    s_branch L_mlf_pub
L_mlf_alt:
    buffer_store_dwordx4 v[148:151], v166, s[44:47], s65 offen sc1
L_mlf_pub:
    s_mov_b64 exec, -1
L_mpf_skip:
    v_and_b32_dpp v32, v21, v12 row_newbcast:0 row_mask:0xf bank_mask:0xf
    v_and_b32_dpp v33, v21, v13 row_newbcast:0 row_mask:0xf bank_mask:0xf
    v_and_b32_dpp v34, v21, v14 row_newbcast:0 row_mask:0xf bank_mask:0xf
    v_and_b32_dpp v35, v21, v15 row_newbcast:0 row_mask:0xf bank_mask:0xf
    v_and_b32_dpp v36, v21, v12 row_newbcast:8 row_mask:0xf bank_mask:0xf
    v_and_b32_dpp v37, v21, v13 row_newbcast:8 row_mask:0xf bank_mask:0xf
    v_and_b32_dpp v38, v21, v14 row_newbcast:8 row_mask:0xf bank_mask:0xf
    v_and_b32_dpp v39, v21, v15 row_newbcast:8 row_mask:0xf bank_mask:0xf
    v_and_b32_dpp v40, v21, v12 row_newbcast:4 row_mask:0xf bank_mask:0xf
    v_and_b32_dpp v41, v21, v13 row_newbcast:4 row_mask:0xf bank_mask:0xf
    v_and_b32_dpp v42, v21, v14 row_newbcast:4 row_mask:0xf bank_mask:0xf
    v_and_b32_dpp v43, v21, v15 row_newbcast:4 row_mask:0xf bank_mask:0xf
    v_and_b32_dpp v44, v21, v12 row_newbcast:12 row_mask:0xf bank_mask:0xf
    v_and_b32_dpp v45, v21, v13 row_newbcast:12 row_mask:0xf bank_mask:0xf
    v_and_b32_dpp v46, v21, v14 row_newbcast:12 row_mask:0xf bank_mask:0xf
    v_and_b32_dpp v47, v21, v15 row_newbcast:12 row_mask:0xf bank_mask:0xf
    v_mfma_f32_16x16x32_bf16 v[16:19], v[32:35], v[192:195], v[16:19]
    v_mfma_f32_16x16x32_bf16 v[16:19], v[36:39], v[196:199], v[16:19]
    v_mfma_f32_16x16x32_bf16 v[16:19], v[40:43], v[200:203], v[16:19]
    v_mfma_f32_16x16x32_bf16 v[16:19], v[44:47], v[204:207], v[16:19]
    s_waitcnt vmcnt(3)
    s_xor_b32 s69, s68, 98304
    buffer_load_dwordx4 v[224:227], v4, s[40:43], s69 offen offset:0 nt
    s_waitcnt vmcnt(3)
    buffer_load_dwordx4 v[228:231], v4, s[40:43], s69 offen offset:2048 nt
    s_waitcnt vmcnt(3)
    buffer_load_dwordx4 v[232:235], v4, s[40:43], s69 offen offset:1024 nt
    s_waitcnt vmcnt(3)
    buffer_load_dwordx4 v[236:239], v4, s[40:43], s69 offen offset:3072 nt
    v_and_b32_dpp v32, v22, v12 row_newbcast:0 row_mask:0xf bank_mask:0xf
    v_and_b32_dpp v33, v22, v13 row_newbcast:0 row_mask:0xf bank_mask:0xf
    v_and_b32_dpp v34, v22, v14 row_newbcast:0 row_mask:0xf bank_mask:0xf
    v_and_b32_dpp v35, v22, v15 row_newbcast:0 row_mask:0xf bank_mask:0xf
    v_and_b32_dpp v36, v22, v12 row_newbcast:8 row_mask:0xf bank_mask:0xf
    v_and_b32_dpp v37, v22, v13 row_newbcast:8 row_mask:0xf bank_mask:0xf
    v_and_b32_dpp v38, v22, v14 row_newbcast:8 row_mask:0xf bank_mask:0xf
    v_and_b32_dpp v39, v22, v15 row_newbcast:8 row_mask:0xf bank_mask:0xf
    v_and_b32_dpp v40, v22, v12 row_newbcast:4 row_mask:0xf bank_mask:0xf
    v_and_b32_dpp v41, v22, v13 row_newbcast:4 row_mask:0xf bank_mask:0xf
    v_and_b32_dpp v42, v22, v14 row_newbcast:4 row_mask:0xf bank_mask:0xf
    v_and_b32_dpp v43, v22, v15 row_newbcast:4 row_mask:0xf bank_mask:0xf
    v_and_b32_dpp v44, v22, v12 row_newbcast:12 row_mask:0xf bank_mask:0xf
    v_and_b32_dpp v45, v22, v13 row_newbcast:12 row_mask:0xf bank_mask:0xf
    v_and_b32_dpp v46, v22, v14 row_newbcast:12 row_mask:0xf bank_mask:0xf
    v_and_b32_dpp v47, v22, v15 row_newbcast:12 row_mask:0xf bank_mask:0xf
    v_mfma_f32_16x16x32_bf16 v[16:19], v[32:35], v[208:211], v[16:19]
    v_mfma_f32_16x16x32_bf16 v[16:19], v[36:39], v[212:215], v[16:19]
    v_mfma_f32_16x16x32_bf16 v[16:19], v[40:43], v[216:219], v[16:19]
    v_mfma_f32_16x16x32_bf16 v[16:19], v[44:47], v[220:223], v[16:19]
    s_waitcnt vmcnt(3)
    s_xor_b32 s69, s68, 131072
    buffer_load_dwordx4 v[240:243], v4, s[40:43], s69 offen offset:0 nt
    s_waitcnt vmcnt(3)
    buffer_load_dwordx4 v[244:247], v4, s[40:43], s69 offen offset:2048 nt
    s_waitcnt vmcnt(3)
    buffer_load_dwordx4 v[248:251], v4, s[40:43], s69 offen offset:1024 nt
    s_waitcnt vmcnt(3)
    buffer_load_dwordx4 v[252:255], v4, s[40:43], s69 offen offset:3072 nt
    s_cmp_lg_u32 s57, 0
    s_cbranch_scc1 L_mgf_skip
    v_and_b32 v145, 3, v1
    v_lshlrev_b32 v145, 7, v145
    s_lshr_b32 s80, s70, 2
    s_lshl_b32 s80, s80, 9
    s_add_u32 s80, s80, 655360
    s_mov_b64 exec, 0xff
    buffer_load_dwordx4 v[148:151], v145, s[44:47], s80 offen sc1
    s_mov_b64 exec, -1
L_mgf_skip:
    v_and_b32_dpp v32, v23, v12 row_newbcast:0 row_mask:0xf bank_mask:0xf
    v_and_b32_dpp v33, v23, v13 row_newbcast:0 row_mask:0xf bank_mask:0xf
    v_and_b32_dpp v34, v23, v14 row_newbcast:0 row_mask:0xf bank_mask:0xf
    v_and_b32_dpp v35, v23, v15 row_newbcast:0 row_mask:0xf bank_mask:0xf
    v_and_b32_dpp v36, v23, v12 row_newbcast:8 row_mask:0xf bank_mask:0xf
    v_and_b32_dpp v37, v23, v13 row_newbcast:8 row_mask:0xf bank_mask:0xf
    v_and_b32_dpp v38, v23, v14 row_newbcast:8 row_mask:0xf bank_mask:0xf
    v_and_b32_dpp v39, v23, v15 row_newbcast:8 row_mask:0xf bank_mask:0xf
    v_and_b32_dpp v40, v23, v12 row_newbcast:4 row_mask:0xf bank_mask:0xf
    v_and_b32_dpp v41, v23, v13 row_newbcast:4 row_mask:0xf bank_mask:0xf
    v_and_b32_dpp v42, v23, v14 row_newbcast:4 row_mask:0xf bank_mask:0xf
    v_and_b32_dpp v43, v23, v15 row_newbcast:4 row_mask:0xf bank_mask:0xf
    v_and_b32_dpp v44, v23, v12 row_newbcast:12 row_mask:0xf bank_mask:0xf
    v_and_b32_dpp v45, v23, v13 row_newbcast:12 row_mask:0xf bank_mask:0xf
    v_and_b32_dpp v46, v23, v14 row_newbcast:12 row_mask:0xf bank_mask:0xf
    v_and_b32_dpp v47, v23, v15 row_newbcast:12 row_mask:0xf bank_mask:0xf
    v_mfma_f32_16x16x32_bf16 v[16:19], v[32:35], v[224:227], v[16:19]
    v_mfma_f32_16x16x32_bf16 v[16:19], v[36:39], v[228:231], v[16:19]
    v_mfma_f32_16x16x32_bf16 v[16:19], v[40:43], v[232:235], v[16:19]
    v_mfma_f32_16x16x32_bf16 v[16:19], v[44:47], v[236:239], v[16:19]
    s_waitcnt vmcnt(3)
    s_xor_b32 s69, s68, 163840
    buffer_load_dwordx4 v[176:179], v4, s[40:43], s69 offen offset:0 nt
    s_waitcnt vmcnt(3)
    buffer_load_dwordx4 v[180:183], v4, s[40:43], s69 offen offset:2048 nt
    s_waitcnt vmcnt(3)
    buffer_load_dwordx4 v[184:187], v4, s[40:43], s69 offen offset:1024 nt
    s_waitcnt vmcnt(3)
    buffer_load_dwordx4 v[188:191], v4, s[40:43], s69 offen offset:3072 nt
    s_cmp_lg_u32 s57, 0
    s_cbranch_scc1 L_mff_skip
    s_waitcnt vmcnt(4)
    s_mov_b32 s64, 0x20000
L_mf_chk:
    s_mov_b64 exec, 0xff
    v_xor_b32 v148, s59, v148
    v_xor_b32 v149, s60, v149
    v_xor_b32 v150, s61, v150
    v_xor_b32 v151, s62, v151
    v_or3_b32 v5, v148, v149, v150
    v_or_b32 v5, v5, v151
    v_cmp_ne_u32_sdwa vcc, v5, 0 src0_sel:BYTE_0 src1_sel:DWORD
    s_mov_b64 exec, -1
    s_cbranch_vccnz L_mf_again
L_mf_ok:
    v_max_f32_dpp v150, v148, v148 quad_perm:[1,0,3,2] row_mask:0xf bank_mask:0xf
    s_nop 1
    v_max_f32_dpp v150, v150, v150 quad_perm:[2,3,0,1] row_mask:0xf bank_mask:0xf
    v_sub_f32 v148, v148, v150
    v_sub_f32 v151, v152, v150
    v_mul_f32 v148, 0x3fb8aa3b, v148
    v_mul_f32 v151, 0x3fb8aa3b, v151
    v_exp_f32 v148, v148
    v_exp_f32 v151, v151
    v_mul_f32 v149, v149, v148
    s_nop 1
    v_add_f32_dpp v149, v149, v149 quad_perm:[1,0,3,2] row_mask:0xf bank_mask:0xf
    s_nop 1
    v_add_f32_dpp v149, v149, v149 quad_perm:[2,3,0,1] row_mask:0xf bank_mask:0xf
    v_rcp_f32 v149, v149
    s_nop 0
    v_mul_f32 v151, v151, v149
    s_nop 0
    v_readlane_b32 s65, v151, 0
    s_nop 1
    v_mov_b32 v112, s65
    v_readlane_b32 s65, v151, 1
    s_nop 1
    v_mov_b32 v113, s65
    v_readlane_b32 s65, v151, 2
    s_nop 1
    v_mov_b32 v114, s65
    v_readlane_b32 s65, v151, 3
    s_nop 1
    v_mov_b32 v115, s65
    v_readlane_b32 s65, v151, 4
    s_nop 1
    v_mov_b32 v116, s65
    v_readlane_b32 s65, v151, 5
    s_nop 1
    v_mov_b32 v117, s65
    v_readlane_b32 s65, v151, 6
    s_nop 1
    v_mov_b32 v118, s65
    v_readlane_b32 s65, v151, 7
    s_nop 1
    v_mov_b32 v119, s65
L_mff_skip:
    v_and_b32_dpp v32, v24, v12 row_newbcast:0 row_mask:0xf bank_mask:0xf
    v_and_b32_dpp v33, v24, v13 row_newbcast:0 row_mask:0xf bank_mask:0xf
    v_and_b32_dpp v34, v24, v14 row_newbcast:0 row_mask:0xf bank_mask:0xf
    v_and_b32_dpp v35, v24, v15 row_newbcast:0 row_mask:0xf bank_mask:0xf
    v_and_b32_dpp v36, v24, v12 row_newbcast:8 row_mask:0xf bank_mask:0xf
    v_and_b32_dpp v37, v24, v13 row_newbcast:8 row_mask:0xf bank_mask:0xf
    v_and_b32_dpp v38, v24, v14 row_newbcast:8 row_mask:0xf bank_mask:0xf
    v_and_b32_dpp v39, v24, v15 row_newbcast:8 row_mask:0xf bank_mask:0xf
    v_and_b32_dpp v40, v24, v12 row_newbcast:4 row_mask:0xf bank_mask:0xf
    v_and_b32_dpp v41, v24, v13 row_newbcast:4 row_mask:0xf bank_mask:0xf
    v_and_b32_dpp v42, v24, v14 row_newbcast:4 row_mask:0xf bank_mask:0xf
    v_and_b32_dpp v43, v24, v15 row_newbcast:4 row_mask:0xf bank_mask:0xf
    v_and_b32_dpp v44, v24, v12 row_newbcast:12 row_mask:0xf bank_mask:0xf
    v_and_b32_dpp v45, v24, v13 row_newbcast:12 row_mask:0xf bank_mask:0xf
    v_and_b32_dpp v46, v24, v14 row_newbcast:12 row_mask:0xf bank_mask:0xf
    v_and_b32_dpp v47, v24, v15 row_newbcast:12 row_mask:0xf bank_mask:0xf
    v_mfma_f32_16x16x32_bf16 v[16:19], v[32:35], v[240:243], v[16:19]
    v_mfma_f32_16x16x32_bf16 v[16:19], v[36:39], v[244:247], v[16:19]
    v_mfma_f32_16x16x32_bf16 v[16:19], v[40:43], v[248:251], v[16:19]
    v_mfma_f32_16x16x32_bf16 v[16:19], v[44:47], v[252:255], v[16:19]
    s_waitcnt vmcnt(3)
    s_xor_b32 s69, s68, 196608
    buffer_load_dwordx4 v[192:195], v4, s[40:43], s69 offen offset:0 nt
    s_waitcnt vmcnt(3)
    buffer_load_dwordx4 v[196:199], v4, s[40:43], s69 offen offset:2048 nt
    s_waitcnt vmcnt(3)
    buffer_load_dwordx4 v[200:203], v4, s[40:43], s69 offen offset:1024 nt
    s_waitcnt vmcnt(3)
    buffer_load_dwordx4 v[204:207], v4, s[40:43], s69 offen offset:3072 nt
    v_and_b32_dpp v32, v25, v12 row_newbcast:0 row_mask:0xf bank_mask:0xf
    v_and_b32_dpp v33, v25, v13 row_newbcast:0 row_mask:0xf bank_mask:0xf
    v_and_b32_dpp v34, v25, v14 row_newbcast:0 row_mask:0xf bank_mask:0xf
    v_and_b32_dpp v35, v25, v15 row_newbcast:0 row_mask:0xf bank_mask:0xf
    v_and_b32_dpp v36, v25, v12 row_newbcast:8 row_mask:0xf bank_mask:0xf
    v_and_b32_dpp v37, v25, v13 row_newbcast:8 row_mask:0xf bank_mask:0xf
    v_and_b32_dpp v38, v25, v14 row_newbcast:8 row_mask:0xf bank_mask:0xf
    v_and_b32_dpp v39, v25, v15 row_newbcast:8 row_mask:0xf bank_mask:0xf
    v_and_b32_dpp v40, v25, v12 row_newbcast:4 row_mask:0xf bank_mask:0xf
    v_and_b32_dpp v41, v25, v13 row_newbcast:4 row_mask:0xf bank_mask:0xf
    v_and_b32_dpp v42, v25, v14 row_newbcast:4 row_mask:0xf bank_mask:0xf
    v_and_b32_dpp v43, v25, v15 row_newbcast:4 row_mask:0xf bank_mask:0xf
    v_and_b32_dpp v44, v25, v12 row_newbcast:12 row_mask:0xf bank_mask:0xf
    v_and_b32_dpp v45, v25, v13 row_newbcast:12 row_mask:0xf bank_mask:0xf
    v_and_b32_dpp v46, v25, v14 row_newbcast:12 row_mask:0xf bank_mask:0xf
    v_and_b32_dpp v47, v25, v15 row_newbcast:12 row_mask:0xf bank_mask:0xf
    v_mfma_f32_16x16x32_bf16 v[16:19], v[32:35], v[176:179], v[16:19]
    v_mfma_f32_16x16x32_bf16 v[16:19], v[36:39], v[180:183], v[16:19]
    v_mfma_f32_16x16x32_bf16 v[16:19], v[40:43], v[184:187], v[16:19]
    v_mfma_f32_16x16x32_bf16 v[16:19], v[44:47], v[188:191], v[16:19]
    s_waitcnt vmcnt(3)
    s_xor_b32 s69, s68, 229376
    buffer_load_dwordx4 v[208:211], v4, s[40:43], s69 offen offset:0 nt
    s_waitcnt vmcnt(3)
    buffer_load_dwordx4 v[212:215], v4, s[40:43], s69 offen offset:2048 nt
    s_waitcnt vmcnt(3)
    buffer_load_dwordx4 v[216:219], v4, s[40:43], s69 offen offset:1024 nt
    s_waitcnt vmcnt(3)
    buffer_load_dwordx4 v[220:223], v4, s[40:43], s69 offen offset:3072 nt
    v_and_b32_dpp v32, v26, v12 row_newbcast:0 row_mask:0xf bank_mask:0xf
    v_and_b32_dpp v33, v26, v13 row_newbcast:0 row_mask:0xf bank_mask:0xf
    v_and_b32_dpp v34, v26, v14 row_newbcast:0 row_mask:0xf bank_mask:0xf
    v_and_b32_dpp v35, v26, v15 row_newbcast:0 row_mask:0xf bank_mask:0xf
    v_and_b32_dpp v36, v26, v12 row_newbcast:8 row_mask:0xf bank_mask:0xf
    v_and_b32_dpp v37, v26, v13 row_newbcast:8 row_mask:0xf bank_mask:0xf
    v_and_b32_dpp v38, v26, v14 row_newbcast:8 row_mask:0xf bank_mask:0xf
    v_and_b32_dpp v39, v26, v15 row_newbcast:8 row_mask:0xf bank_mask:0xf
    v_and_b32_dpp v40, v26, v12 row_newbcast:4 row_mask:0xf bank_mask:0xf
    v_and_b32_dpp v41, v26, v13 row_newbcast:4 row_mask:0xf bank_mask:0xf
    v_and_b32_dpp v42, v26, v14 row_newbcast:4 row_mask:0xf bank_mask:0xf
    v_and_b32_dpp v43, v26, v15 row_newbcast:4 row_mask:0xf bank_mask:0xf
    v_and_b32_dpp v44, v26, v12 row_newbcast:12 row_mask:0xf bank_mask:0xf
    v_and_b32_dpp v45, v26, v13 row_newbcast:12 row_mask:0xf bank_mask:0xf
    v_and_b32_dpp v46, v26, v14 row_newbcast:12 row_mask:0xf bank_mask:0xf
    v_and_b32_dpp v47, v26, v15 row_newbcast:12 row_mask:0xf bank_mask:0xf
    v_mfma_f32_16x16x32_bf16 v[16:19], v[32:35], v[192:195], v[16:19]
    v_mfma_f32_16x16x32_bf16 v[16:19], v[36:39], v[196:199], v[16:19]
    v_mfma_f32_16x16x32_bf16 v[16:19], v[40:43], v[200:203], v[16:19]
    v_mfma_f32_16x16x32_bf16 v[16:19], v[44:47], v[204:207], v[16:19]
    v_and_b32_dpp v32, v27, v12 row_newbcast:0 row_mask:0xf bank_mask:0xf
    v_and_b32_dpp v33, v27, v13 row_newbcast:0 row_mask:0xf bank_mask:0xf
    v_and_b32_dpp v34, v27, v14 row_newbcast:0 row_mask:0xf bank_mask:0xf
    v_and_b32_dpp v35, v27, v15 row_newbcast:0 row_mask:0xf bank_mask:0xf
    v_and_b32_dpp v36, v27, v12 row_newbcast:8 row_mask:0xf bank_mask:0xf
    v_and_b32_dpp v37, v27, v13 row_newbcast:8 row_mask:0xf bank_mask:0xf
    v_and_b32_dpp v38, v27, v14 row_newbcast:8 row_mask:0xf bank_mask:0xf
    v_and_b32_dpp v39, v27, v15 row_newbcast:8 row_mask:0xf bank_mask:0xf
    v_and_b32_dpp v40, v27, v12 row_newbcast:4 row_mask:0xf bank_mask:0xf
    v_and_b32_dpp v41, v27, v13 row_newbcast:4 row_mask:0xf bank_mask:0xf
    v_and_b32_dpp v42, v27, v14 row_newbcast:4 row_mask:0xf bank_mask:0xf
    v_and_b32_dpp v43, v27, v15 row_newbcast:4 row_mask:0xf bank_mask:0xf
    v_and_b32_dpp v44, v27, v12 row_newbcast:12 row_mask:0xf bank_mask:0xf
    v_and_b32_dpp v45, v27, v13 row_newbcast:12 row_mask:0xf bank_mask:0xf
    v_and_b32_dpp v46, v27, v14 row_newbcast:12 row_mask:0xf bank_mask:0xf
    v_and_b32_dpp v47, v27, v15 row_newbcast:12 row_mask:0xf bank_mask:0xf
    s_waitcnt vmcnt(3)
    v_mfma_f32_16x16x32_bf16 v[16:19], v[32:35], v[208:211], v[16:19]
    s_mov_b32 s48, s24
    s_mov_b32 s49, s25
    s_mov_b32 s50, 1409024
    s_mov_b32 s51, 0x20000
    v_and_b32 v0, 2, v2
    v_and_b32 v5, 8, v1
    v_add_u32 v0, v5, v0
    v_and_b32 v5, 1, v2
    v_lshl_add_u32 v0, v0, 1, v5
    v_mul_u32_u24 v0, 1024, v0
    v_lshlrev_b32 v5, 1, v2
    v_xor_b32 v5, v1, v5
    v_and_b32 v5, 7, v5
    v_lshl_add_u32 v0, v5, 4, v0
    s_lshl_b32 s76, s53, 16
    s_lshl_b32 s66, s57, 7
    s_add_u32 m0, s77, 81920
    s_add_u32 s76, s76, s66
    buffer_load_dwordx4 v0, s[48:51], s76 offen nt lds
    s_waitcnt vmcnt(3)
    v_mfma_f32_16x16x32_bf16 v[16:19], v[36:39], v[212:215], v[16:19]
    s_add_u32 m0, s77, 82944
    s_add_u32 s76, s76, 2048
    buffer_load_dwordx4 v0, s[48:51], s76 offen nt lds
    s_waitcnt vmcnt(3)
    v_mfma_f32_16x16x32_bf16 v[16:19], v[40:43], v[216:219], v[16:19]
    s_add_u32 m0, s77, 83968
    s_add_u32 s76, s76, 6144
    buffer_load_dwordx4 v0, s[48:51], s76 offen nt lds
    s_waitcnt vmcnt(3)
    v_mfma_f32_16x16x32_bf16 v[16:19], v[44:47], v[220:223], v[16:19]
    s_add_u32 m0, s77, 84992
    s_add_u32 s76, s76, 2048
    buffer_load_dwordx4 v0, s[48:51], s76 offen nt lds
    s_branch L_tail
L_qfarn:
    v_lshrrev_b32 v5, 5, v1
    v_lshlrev_b32 v5, 12, v5
    v_and_b32 v6, 31, v1
    v_lshl_add_u32 v5, v6, 4, v5
    s_lshl_b32 s65, s54, 13
    s_lshl_b32 s66, s55, 9
    s_add_u32 s65, s65, s66
    s_add_u32 s65, s65, 262144
    buffer_store_dwordx4 v[16:19], v5, s[44:47], s65 offen sc1
    s_branch L_xfn_skip
L_qn_again:
    s_sub_u32 s64, s64, 1
    s_cbranch_scc1 L_qn_ok
    buffer_load_dwordx4 v[32:35], v7, s[44:47], s78 offen offset:0 sc1
    buffer_load_dwordx4 v[36:39], v7, s[44:47], s78 offen offset:1024 sc1
    buffer_load_dwordx4 v[40:43], v7, s[44:47], s78 offen offset:2048 sc1
    buffer_load_dwordx4 v[44:47], v7, s[44:47], s78 offen offset:3072 sc1
    s_waitcnt vmcnt(0)
    s_branch L_qn_chk
L_mn_again:
    s_sub_u32 s64, s64, 1
    s_cbranch_scc1 L_mn_ok
    s_mov_b64 exec, 0xff
    buffer_load_dwordx4 v[148:151], v145, s[44:47], s80 offen sc1
    s_mov_b64 exec, -1
    s_waitcnt vmcnt(0)
    s_branch L_mn_chk
L_qfarw:
    v_lshrrev_b32 v5, 5, v1
    v_lshlrev_b32 v5, 12, v5
    v_and_b32 v6, 31, v1
    v_lshl_add_u32 v5, v6, 4, v5
    s_lshl_b32 s65, s54, 13
    s_lshl_b32 s66, s55, 9
    s_add_u32 s65, s65, s66
    s_add_u32 s65, s65, 262144
    buffer_store_dwordx4 v[16:19], v5, s[44:47], s65 offen sc1
    s_branch L_xfw_skip
L_qw_again:
    s_sub_u32 s64, s64, 1
    s_cbranch_scc1 L_qw_ok
    buffer_load_dwordx4 v[32:35], v7, s[44:47], s78 offen offset:0 sc1
    buffer_load_dwordx4 v[36:39], v7, s[44:47], s78 offen offset:1024 sc1
    buffer_load_dwordx4 v[40:43], v7, s[44:47], s78 offen offset:2048 sc1
    buffer_load_dwordx4 v[44:47], v7, s[44:47], s78 offen offset:3072 sc1
    s_waitcnt vmcnt(0)
    s_branch L_qw_chk
L_mw_again:
    s_sub_u32 s64, s64, 1
    s_cbranch_scc1 L_mw_ok
    s_mov_b64 exec, 0xff
    buffer_load_dwordx4 v[148:151], v145, s[44:47], s80 offen sc1
    s_mov_b64 exec, -1
    s_waitcnt vmcnt(0)
    s_branch L_mw_chk
L_qfarx:
    v_lshrrev_b32 v5, 5, v1
    v_lshlrev_b32 v5, 12, v5
    v_and_b32 v6, 31, v1
    v_lshl_add_u32 v5, v6, 4, v5
    s_lshl_b32 s65, s54, 13
    s_lshl_b32 s66, s55, 9
    s_add_u32 s65, s65, s66
    s_add_u32 s65, s65, 262144
    buffer_store_dwordx4 v[16:19], v5, s[44:47], s65 offen sc1
    s_branch L_xfx_skip
L_qx_again:
    s_sub_u32 s64, s64, 1
    s_cbranch_scc1 L_qx_ok
    buffer_load_dwordx4 v[32:35], v7, s[44:47], s78 offen offset:0 sc1
    buffer_load_dwordx4 v[36:39], v7, s[44:47], s78 offen offset:1024 sc1
    buffer_load_dwordx4 v[40:43], v7, s[44:47], s78 offen offset:2048 sc1
    buffer_load_dwordx4 v[44:47], v7, s[44:47], s78 offen offset:3072 sc1
    s_waitcnt vmcnt(0)
    s_branch L_qx_chk
L_mx_again:
    s_sub_u32 s64, s64, 1
    s_cbranch_scc1 L_mx_ok
    s_mov_b64 exec, 0xff
    buffer_load_dwordx4 v[148:151], v145, s[44:47], s80 offen sc1
    s_mov_b64 exec, -1
    s_waitcnt vmcnt(0)
    s_branch L_mx_chk
L_qfarf:
    v_lshrrev_b32 v5, 5, v1
    v_lshlrev_b32 v5, 12, v5
    v_and_b32 v6, 31, v1
    v_lshl_add_u32 v5, v6, 4, v5
    s_lshl_b32 s65, s54, 13
    s_lshl_b32 s66, s55, 9
    s_add_u32 s65, s65, s66
    s_add_u32 s65, s65, 262144
    buffer_store_dwordx4 v[16:19], v5, s[44:47], s65 offen sc1
    s_branch L_xff_skip
L_qf_again:
    s_sub_u32 s64, s64, 1
    s_cbranch_scc1 L_qf_ok
    buffer_load_dwordx4 v[32:35], v7, s[44:47], s78 offen offset:0 sc1
    buffer_load_dwordx4 v[36:39], v7, s[44:47], s78 offen offset:1024 sc1
    buffer_load_dwordx4 v[40:43], v7, s[44:47], s78 offen offset:2048 sc1
    buffer_load_dwordx4 v[44:47], v7, s[44:47], s78 offen offset:3072 sc1
    s_waitcnt vmcnt(0)
    s_branch L_qf_chk
L_mf_again:
    s_sub_u32 s64, s64, 1
    s_cbranch_scc1 L_mf_ok
    s_mov_b64 exec, 0xff
    buffer_load_dwordx4 v[148:151], v145, s[44:47], s80 offen sc1
    s_mov_b64 exec, -1
    s_waitcnt vmcnt(0)
    s_branch L_mf_chk
L_end:
    s_endpgm
.if (. - L_pc) > 32768
.error "code prefetch too short"
.endif
.fill (32768 - (. - L_pc)) / 4, 4, 0xbf810000
.section .rodata,"a"
.p2align 6
.amdhsa_kernel sequential_preLN__mha_block_cached__dense_activation_squared_relu__decode_kernel
  .amdhsa_next_free_vgpr 256
  .amdhsa_next_free_sgpr 102
  .amdhsa_accum_offset 256
  .amdhsa_group_segment_fixed_size 0
  .amdhsa_kernarg_size 104
  .amdhsa_user_sgpr_count 2
  .amdhsa_user_sgpr_kernarg_segment_ptr 1
  .amdhsa_system_sgpr_workgroup_id_x 1
  .amdhsa_float_denorm_mode_32 3
.end_amdhsa_kernel
```
